```python
import torch

def _softmax(x, axis=-1):
    return torch.softmax(x, dim=axis)
def _gelu(x):
    return torch.nn.functional.gelu(x, approximate="tanh")
def _silu(x):
    return torch.nn.functional.silu(x)
def _sigmoid(x):
    return torch.sigmoid(x)
def _layernorm(x, axis=-1, eps=1e-5):
    m = x.mean(dim=axis, keepdim=True)
    v = x.var(dim=axis, keepdim=True, unbiased=False)
    return (x - m) / torch.sqrt(v + eps)
def _scatter_add(tgt, idx, src, axis=0):
    return tgt.clone().index_add_(axis, idx, src)
def _segment_sum(src, seg, n):
    out = torch.zeros((n,) + src.shape[1:], dtype=src.dtype)
    return out.index_add_(0, seg, src)
def _pad(x, pw):
    flat = tuple(v for pair in reversed(pw) for v in pair)
    return torch.nn.functional.pad(x, flat)

kernel_name = 'sequential_preLN__linear_attn_block__mixer_channel_mlp__prompt'

def setup_inputs():

    _w = (lambda a: (lambda t: t.to(torch.bfloat16) if t.is_floating_point() else t)(torch.as_tensor(a)))
    def _A_setup():
        B, S, D = 1, 2048, 512
        return {
            "x": _w((lambda *s: torch.randn(*s, dtype=torch.bfloat16) * 0.05)(B, S, D)),
            "wqkv": _w((lambda *s: torch.randn(*s, dtype=torch.bfloat16) * 0.1)(D, 3 * D)),
            "wo": _w((lambda *s: torch.randn(*s, dtype=torch.bfloat16) * 0.05)(D, D)),
        }
    _A_in = _A_setup()

    def _B_setup():
        B, S, D, F = 1, 2048, 512, 1792
        return {
            "x": _w((lambda *s: torch.randn(*s, dtype=torch.bfloat16) * 0.05)(B, S, D)),
            "w1": _w((lambda *s: torch.randn(*s, dtype=torch.bfloat16) * 3.2)(D, F) * (D ** -0.5)),
            "b1": _w((lambda *s: torch.randn(*s, dtype=torch.bfloat16) * 0.8)(F)),
            "w2": _w((lambda *s: torch.randn(*s, dtype=torch.bfloat16) * 0.05)(F, D) * (F ** -0.5)),
            "b2": _w((lambda *s: torch.randn(*s, dtype=torch.bfloat16) * 0.05)(D)),
        }
    _B_in = _B_setup()

    return {
        "A_x": _A_in["x"],
        "A_wqkv": _A_in["wqkv"],
        "A_wo": _A_in["wo"],
        "B_x": _B_in["x"],
        "B_w1": _B_in["w1"],
        "B_b1": _B_in["b1"],
        "B_w2": _B_in["w2"],
        "B_b2": _B_in["b2"],
    }

def reference(A_x, A_wqkv, A_wo, B_x, B_w1, B_b1, B_w2, B_b2):
    def _A_ref(x, wqkv, wo):
        B, S, D = x.shape
        H = 32; Dh = D // H
        qkv = (lambda x, *d: x.permute(*d))((x @ wqkv).reshape(B, S, 3, H, Dh), 2, 0, 3, 1, 4)
        q, k, v = qkv[0], qkv[1], qkv[2]
        phi = lambda t: torch.where(t > 0, t + 1, torch.exp(t)) + 1e-6
        pq, pk = phi(q), phi(k)
        kv = torch.einsum("bhsd,bhse->bhde", pk, v)
        z = torch.einsum("bhsd->bhd", pk)
        num = torch.einsum("bhqd,bhde->bhqe", pq, kv)
        den = torch.einsum("bhqd,bhd->bhq", pq, z)[..., None] + 1e-6
        o = num / den
        return (lambda x, *d: x.permute(*d))(o, 0, 2, 1, 3).reshape(B, S, D) @ wo

    def _B_ref(x, w1, b1, w2, b2):
        y = _layernorm(x, axis=-1)
        h = _gelu(torch.einsum("bsd,df->bsf", y, w1) + b1)
        return torch.einsum("bsf,fd->bsd", h, w2) + b2

    x = A_x
    h = x + _A_ref(_layernorm(x, axis=-1), A_wqkv, A_wo)
    h2 = h + _B_ref(_layernorm(h, axis=-1), B_w1, B_b1, B_w2, B_b2)
    return h2
```

```asm
; @launch kernel=fused_kernel grid=(256,1,1) block=(768,1,1) lds=163840
.amdgcn_target "amdgcn-amd-amdhsa--gfx950"
.text
.p2align 12
.globl fused_kernel
.p2align 8
.type fused_kernel,@function
fused_kernel:
    s_cmp_ge_u32 s2, 256
    s_cbranch_scc1 KF_END
    s_load_dwordx16 s[16:31], s[0:1], 0
    s_load_dwordx4 s[32:35], s[0:1], 64
    s_load_dwordx2 s[36:37], s[0:1], 80
    s_mov_b64 exec, -1
    v_lshrrev_b32 v4, 6, v0
    v_and_b32 v1, 63, v0
    v_readfirstlane_b32 s3, v4
    v_and_b32 v2, 15, v1
    v_lshrrev_b32 v3, 4, v1
    s_bfe_u32 s4, s2, 0x20001
    s_and_b32 s5, s2, 1
    s_lshr_b32 s8, s2, 3
    v_lshlrev_b32 v4, 4, v1
    s_and_b32 s6, s8, 7
    s_lshl_b32 s9, s4, 3
    s_add_u32 s6, s6, s9
    s_lshr_b32 s7, s8, 3
    s_lshl_b32 s9, s5, 2
    s_add_u32 s7, s7, s9
    s_cmp_lt_u32 s3, 4
    s_cbranch_scc1 QK_ENTRY
    s_cmp_lt_u32 s3, 8
    s_cbranch_scc1 QS_ENTRY
QL_ENTRY:
    s_sub_u32 s62, s3, 8
    v_lshrrev_b32 v8, 3, v1
    v_and_b32 v5, 7, v1
    v_xor_b32 v5, v5, v8
    v_lshlrev_b32 v8, 10, v8
    v_lshl_add_u32 v8, v5, 4, v8
    v_bfe_u32 v5, v1, 3, 2
    v_lshrrev_b32 v6, 5, v1
    v_lshl_add_u32 v5, v6, 3, v5
    v_mul_u32_u24 v5, 3072, v5
    v_bfe_u32 v6, v1, 1, 2
    v_bfe_u32 v7, v1, 4, 2
    v_xor_b32 v6, v6, v7
    v_lshl_add_u32 v5, v6, 5, v5
    v_and_b32 v6, 1, v1
    v_lshl_add_u32 v5, v6, 4, v5
    s_lshl_b32 s10, s6, 6
    s_lshl_b32 s11, s62, 4
    s_add_u32 s10, s10, s11
    s_lshl_b32 s10, s10, 10
    s_lshl_b32 s11, s62, 11
    s_and_b32 s12, s62, 1
    s_mul_i32 s12, s12, 98304
    s_lshl_b32 s15, s7, 7
    s_add_u32 s12, s12, s15
    s_lshr_b32 s15, s62, 1
    s_mul_i32 s13, s15, 196608
    s_add_u32 s13, s13, s12
    s_lshl_b32 s15, s15, 10
    s_add_u32 s12, s12, s15
    s_add_u32 s12, s12, 1024
    s_lshl_b32 s14, s62, 12
    s_add_u32 s14, s14, 65536
    s_waitcnt lgkmcnt(0)
    s_mov_b32 s40, s16
    s_and_b32 s41, s17, 0xffff
    s_mov_b32 s42, 2097152
    s_mov_b32 s43, 0x20000
    s_mov_b32 s44, s18
    s_and_b32 s45, s19, 0xffff
    s_mov_b32 s46, 1572864
    s_mov_b32 s47, 0x20000
    s_add_u32 s15, s10, 0
    s_add_u32 m0, s11, 0
    s_nop 0
    buffer_load_dwordx4 v8, s[40:43], s15 offen lds
    s_add_u32 s15, s10, 8192
    s_add_u32 m0, s11, 1024
    s_nop 0
    buffer_load_dwordx4 v8, s[40:43], s15 offen lds
    s_add_u32 s15, s12, 0
    s_add_u32 m0, s14, 0
    s_nop 0
    buffer_load_dwordx4 v5, s[44:47], s15 offen lds
    s_add_u32 s15, s12, 49152
    s_add_u32 m0, s14, 1024
    s_nop 0
    buffer_load_dwordx4 v5, s[44:47], s15 offen lds
    s_add_u32 s15, s12, 12288
    s_add_u32 m0, s14, 2048
    s_nop 0
    buffer_load_dwordx4 v5, s[44:47], s15 offen lds
    s_add_u32 s15, s12, 61440
    s_add_u32 m0, s14, 3072
    s_nop 0
    buffer_load_dwordx4 v5, s[44:47], s15 offen lds
    s_add_u32 s15, s10, 128
    s_add_u32 m0, s11, 8192
    s_nop 0
    buffer_load_dwordx4 v8, s[40:43], s15 offen lds
    s_add_u32 s15, s10, 8320
    s_add_u32 m0, s11, 9216
    s_nop 0
    buffer_load_dwordx4 v8, s[40:43], s15 offen lds
    s_add_u32 s15, s12, 196608
    s_add_u32 m0, s14, 16384
    s_nop 0
    buffer_load_dwordx4 v5, s[44:47], s15 offen lds
    s_add_u32 s15, s12, 245760
    s_add_u32 m0, s14, 17408
    s_nop 0
    buffer_load_dwordx4 v5, s[44:47], s15 offen lds
    s_add_u32 s15, s12, 208896
    s_add_u32 m0, s14, 18432
    s_nop 0
    buffer_load_dwordx4 v5, s[44:47], s15 offen lds
    s_add_u32 s15, s12, 258048
    s_add_u32 m0, s14, 19456
    s_nop 0
    buffer_load_dwordx4 v5, s[44:47], s15 offen lds
    s_mov_b32 s48, s34
    s_and_b32 s49, s35, 0xffff
    s_mov_b32 s50, 256
    s_mov_b32 s51, 0x20000
    v_lshlrev_b32 v12, 5, v1
    v_mov_b32 v13, 163712
    s_lshl_b32 s9, 1, s62
    v_lshlrev_b32 v16, 0, s9
    v_lshlrev_b32 v17, 4, s9
    v_lshlrev_b32 v18, 8, s9
    v_lshlrev_b32 v19, 12, s9
    v_mov_b32 v20, 1
    v_mov_b32 v21, 0x80000000
    s_lshl_b32 s9, s7, 5
    v_mov_b32 v10, s9
    s_add_u32 s39, s9, 4
    s_waitcnt vmcnt(6)
    s_barrier
    s_add_u32 s15, s10, 256
    s_add_u32 m0, s11, 16384
    s_nop 0
    buffer_load_dwordx4 v8, s[40:43], s15 offen lds
    s_add_u32 s15, s10, 8448
    s_add_u32 m0, s11, 17408
    s_nop 0
    buffer_load_dwordx4 v8, s[40:43], s15 offen lds
    s_add_u32 s15, s10, 384
    s_add_u32 m0, s11, 24576
    s_nop 0
    buffer_load_dwordx4 v8, s[40:43], s15 offen lds
    s_add_u32 s15, s10, 8576
    s_add_u32 m0, s11, 25600
    s_nop 0
    buffer_load_dwordx4 v8, s[40:43], s15 offen lds
    s_add_u32 s15, s12, 393216
    s_add_u32 m0, s14, 32768
    s_nop 0
    buffer_load_dwordx4 v5, s[44:47], s15 offen lds
    s_add_u32 s15, s12, 442368
    s_add_u32 m0, s14, 33792
    s_nop 0
    buffer_load_dwordx4 v5, s[44:47], s15 offen lds
    s_add_u32 s15, s12, 405504
    s_add_u32 m0, s14, 34816
    s_nop 0
    buffer_load_dwordx4 v5, s[44:47], s15 offen lds
    s_add_u32 s15, s12, 454656
    s_add_u32 m0, s14, 35840
    s_nop 0
    buffer_load_dwordx4 v5, s[44:47], s15 offen lds
    s_waitcnt vmcnt(8)
    s_barrier
    s_add_u32 s15, s10, 512
    s_add_u32 m0, s11, 32768
    s_nop 0
    buffer_load_dwordx4 v8, s[40:43], s15 offen lds
    s_add_u32 s15, s10, 8704
    s_add_u32 m0, s11, 33792
    s_nop 0
    buffer_load_dwordx4 v8, s[40:43], s15 offen lds
    s_add_u32 s15, s10, 640
    s_add_u32 m0, s11, 40960
    s_nop 0
    buffer_load_dwordx4 v8, s[40:43], s15 offen lds
    s_add_u32 s15, s10, 8832
    s_add_u32 m0, s11, 41984
    s_nop 0
    buffer_load_dwordx4 v8, s[40:43], s15 offen lds
    s_add_u32 s15, s12, 589824
    s_add_u32 m0, s14, 49152
    s_nop 0
    buffer_load_dwordx4 v5, s[44:47], s15 offen lds
    s_add_u32 s15, s12, 638976
    s_add_u32 m0, s14, 50176
    s_nop 0
    buffer_load_dwordx4 v5, s[44:47], s15 offen lds
    s_add_u32 s15, s12, 602112
    s_add_u32 m0, s14, 51200
    s_nop 0
    buffer_load_dwordx4 v5, s[44:47], s15 offen lds
    s_add_u32 s15, s12, 651264
    s_add_u32 m0, s14, 52224
    s_nop 0
    buffer_load_dwordx4 v5, s[44:47], s15 offen lds
    s_waitcnt vmcnt(8)
    s_barrier
    s_add_u32 s15, s10, 768
    s_add_u32 m0, s11, 49152
    s_nop 0
    buffer_load_dwordx4 v8, s[40:43], s15 offen lds
    s_add_u32 s15, s10, 8960
    s_add_u32 m0, s11, 50176
    s_nop 0
    buffer_load_dwordx4 v8, s[40:43], s15 offen lds
    s_add_u32 s15, s10, 896
    s_add_u32 m0, s11, 57344
    s_nop 0
    buffer_load_dwordx4 v8, s[40:43], s15 offen lds
    s_add_u32 s15, s10, 9088
    s_add_u32 m0, s11, 58368
    s_nop 0
    buffer_load_dwordx4 v8, s[40:43], s15 offen lds
    s_add_u32 s15, s12, 786432
    s_add_u32 m0, s14, 65536
    s_nop 0
    buffer_load_dwordx4 v5, s[44:47], s15 offen lds
    s_add_u32 s15, s12, 835584
    s_add_u32 m0, s14, 66560
    s_nop 0
    buffer_load_dwordx4 v5, s[44:47], s15 offen lds
    s_add_u32 s15, s12, 798720
    s_add_u32 m0, s14, 67584
    s_nop 0
    buffer_load_dwordx4 v5, s[44:47], s15 offen lds
    s_add_u32 s15, s12, 847872
    s_add_u32 m0, s14, 68608
    s_nop 0
    buffer_load_dwordx4 v5, s[44:47], s15 offen lds
    s_waitcnt vmcnt(8)
    s_barrier
    s_add_u32 s15, s12, 983040
    s_add_u32 m0, s14, 0
    s_nop 0
    buffer_load_dwordx4 v5, s[44:47], s15 offen lds
    s_add_u32 s15, s12, 1032192
    s_add_u32 m0, s14, 1024
    s_nop 0
    buffer_load_dwordx4 v5, s[44:47], s15 offen lds
    s_add_u32 s15, s12, 995328
    s_add_u32 m0, s14, 2048
    s_nop 0
    buffer_load_dwordx4 v5, s[44:47], s15 offen lds
    s_add_u32 s15, s12, 1044480
    s_add_u32 m0, s14, 3072
    s_nop 0
    buffer_load_dwordx4 v5, s[44:47], s15 offen lds
    s_add_u32 s15, s12, 1179648
    s_add_u32 m0, s14, 16384
    s_nop 0
    buffer_load_dwordx4 v5, s[44:47], s15 offen lds
    s_add_u32 s15, s12, 1228800
    s_add_u32 m0, s14, 17408
    s_nop 0
    buffer_load_dwordx4 v5, s[44:47], s15 offen lds
    s_add_u32 s15, s12, 1191936
    s_add_u32 m0, s14, 18432
    s_nop 0
    buffer_load_dwordx4 v5, s[44:47], s15 offen lds
    s_add_u32 s15, s12, 1241088
    s_add_u32 m0, s14, 19456
    s_nop 0
    buffer_load_dwordx4 v5, s[44:47], s15 offen lds
    s_waitcnt vmcnt(8)
    s_barrier
    s_add_u32 s15, s12, 1376256
    s_add_u32 m0, s14, 32768
    s_nop 0
    buffer_load_dwordx4 v5, s[44:47], s15 offen lds
    s_add_u32 s15, s12, 1425408
    s_add_u32 m0, s14, 33792
    s_nop 0
    buffer_load_dwordx4 v5, s[44:47], s15 offen lds
    s_add_u32 s15, s12, 1388544
    s_add_u32 m0, s14, 34816
    s_nop 0
    buffer_load_dwordx4 v5, s[44:47], s15 offen lds
    s_add_u32 s15, s12, 1437696
    s_add_u32 m0, s14, 35840
    s_nop 0
    buffer_load_dwordx4 v5, s[44:47], s15 offen lds
    s_waitcnt vmcnt(8)
    s_barrier
    s_add_u32 s15, s13, 0
    s_add_u32 m0, s14, 49152
    s_nop 0
    buffer_load_dwordx4 v5, s[44:47], s15 offen lds
    s_add_u32 s15, s13, 49152
    s_add_u32 m0, s14, 50176
    s_nop 0
    buffer_load_dwordx4 v5, s[44:47], s15 offen lds
    s_add_u32 s15, s13, 12288
    s_add_u32 m0, s14, 51200
    s_nop 0
    buffer_load_dwordx4 v5, s[44:47], s15 offen lds
    s_add_u32 s15, s13, 61440
    s_add_u32 m0, s14, 52224
    s_nop 0
    buffer_load_dwordx4 v5, s[44:47], s15 offen lds
    s_waitcnt vmcnt(8)
    s_barrier
    s_add_u32 s15, s13, 393216
    s_add_u32 m0, s14, 65536
    s_nop 0
    buffer_load_dwordx4 v5, s[44:47], s15 offen lds
    s_add_u32 s15, s13, 442368
    s_add_u32 m0, s14, 66560
    s_nop 0
    buffer_load_dwordx4 v5, s[44:47], s15 offen lds
    s_waitcnt vmcnt(6)
    s_barrier
    s_cmp_lg_u32 s62, 0
    s_cbranch_scc1 QL_NS
    s_load_dword s38, s[34:35], s39
QL_NS:
    s_add_u32 s15, s13, 405504
    s_add_u32 m0, s14, 67584
    s_nop 0
    buffer_load_dwordx4 v5, s[44:47], s15 offen lds
    s_add_u32 s15, s13, 454656
    s_add_u32 m0, s14, 68608
    s_nop 0
    buffer_load_dwordx4 v5, s[44:47], s15 offen lds
    s_add_u32 s15, s13, 786432
    s_add_u32 m0, s14, 0
    s_nop 0
    buffer_load_dwordx4 v5, s[44:47], s15 offen lds
    s_add_u32 s15, s13, 835584
    s_add_u32 m0, s14, 1024
    s_nop 0
    buffer_load_dwordx4 v5, s[44:47], s15 offen lds
    s_cmp_lg_u32 s62, 0
    s_cbranch_scc1 QL_NF
    s_waitcnt lgkmcnt(0)
    v_mov_b32 v11, s38
    ds_write_b32 v13, v11 offset:12
    s_nop 1
QL_NF:
    s_add_u32 s15, s13, 798720
    s_add_u32 m0, s14, 2048
    s_nop 0
    buffer_load_dwordx4 v5, s[44:47], s15 offen lds
    s_add_u32 s15, s13, 847872
    s_add_u32 m0, s14, 3072
    s_nop 0
    buffer_load_dwordx4 v5, s[44:47], s15 offen lds
    s_waitcnt vmcnt(8)
    s_mov_b64 exec, 1
    ds_or_b32 v13, v16
    s_mov_b64 exec, -1
    s_mov_b64 exec, 0xff
    buffer_load_dwordx2 v[14:15], v12, s[48:51], 0 offen sc1
    s_mov_b64 exec, -1
    s_add_u32 s15, s13, 1179648
    s_add_u32 m0, s14, 16384
    s_nop 0
    buffer_load_dwordx4 v5, s[44:47], s15 offen lds
    s_add_u32 s15, s13, 1228800
    s_add_u32 m0, s14, 17408
    s_nop 0
    buffer_load_dwordx4 v5, s[44:47], s15 offen lds
    s_add_u32 s15, s13, 1191936
    s_add_u32 m0, s14, 18432
    s_nop 0
    buffer_load_dwordx4 v5, s[44:47], s15 offen lds
    s_add_u32 s15, s13, 1241088
    s_add_u32 m0, s14, 19456
    s_nop 0
    buffer_load_dwordx4 v5, s[44:47], s15 offen lds
    s_waitcnt vmcnt(9)
    s_mov_b64 exec, 1
    ds_or_b32 v13, v17
    s_mov_b64 exec, -1
    s_waitcnt vmcnt(5)
    s_mov_b64 exec, 1
    ds_or_b32 v13, v18
    s_mov_b64 exec, -1
    s_waitcnt vmcnt(0)
    s_mov_b64 exec, 1
    ds_or_b32 v13, v19
    s_mov_b64 exec, -1
    s_cmp_lg_u32 s62, 0
    s_cbranch_scc1 QL_NH
    s_mov_b64 exec, 0xff
    s_mov_b32 s12, 524288
    s_mov_b32 s15, 0
    v_cmp_ne_u32 vcc, -1, v14
    v_cmp_eq_u32 s[60:61], 0, v15
    s_or_b32 s38, vcc_lo, s60
    s_cmp_eq_u32 s38, 0
    s_nop 2
    s_cbranch_scc1 QL_DW
QL_DP:
    buffer_load_dwordx2 v[14:15], v12, s[48:51], 0 offen sc1
    s_waitcnt vmcnt(0)
    v_cmp_ne_u32 vcc, -1, v14
    v_cmp_eq_u32 s[60:61], 0, v15
    s_sub_u32 s12, s12, 1
    s_cmp_eq_u32 s12, 0
    s_nop 2
    s_cbranch_scc1 QL_DW
    s_bitcmp1_b32 s60, s7
    s_cbranch_scc1 QL_DP
    ds_write_b32 v13, v20 offset:12
    s_cmp_lg_u32 vcc_lo, 0
    s_cbranch_scc1 QL_ST
    s_cmp_lg_u32 s60, 0
    s_cbranch_scc1 QL_DP
    s_branch QL_DW
QL_ST:
    s_ff1_i32_b32 s9, vcc_lo
    v_readlane_b32 s11, v14, s9
    s_ff0_i32_b32 s11, s11
    s_lshl_b32 s15, s9, 16
    s_lshl_b32 s11, s11, 8
    s_or_b32 s15, s15, s11
    s_or_b32 s15, s15, 1
QL_DW:
    s_mov_b64 exec, -1
    v_or_b32 v21, s15, v21
    ds_write2_b32 v13, v20, v21 offset0:3 offset1:18
    s_nop 1
QL_NH:
    s_cmp_lg_u32 s62, 1
    s_cbranch_scc1 QL_B9
    s_mov_b64 exec, 0
    s_branch PGS2
CH_K2P_RET:
    s_mov_b64 exec, -1
QL_B9:
QL_QW:
    ds_read2_b32 v[14:15], v13 offset0:17 offset1:18
    s_waitcnt lgkmcnt(0)
    v_readfirstlane_b32 s9, v15
    v_readfirstlane_b32 s11, v14
    s_cmp_eq_u32 s9, 0
    s_nop 3
    s_cbranch_scc1 QL_QW
    s_and_b32 s11, s11, 65535
    s_cmp_lg_u32 s11, 2056
    s_cbranch_scc1 QL_QW
    s_bfe_u32 s6, s9, 0x80008
    s_bfe_u32 s7, s9, 0x80010
    s_bitcmp1_b32 s9, 0
    s_cbranch_scc1 QL_ENTRY
    s_branch KF_LOADER
QK_ENTRY:
    v_and_b32 v7, 7, v2
    v_xor_b32 v7, v7, v3
    v_lshlrev_b32 v5, 7, v2
    v_lshl_add_u32 v5, v7, 4, v5
    v_xor_b32 v6, 64, v5
    v_lshrrev_b32 v7, 2, v2
    v_lshl_add_u32 v9, v3, 2, v7
    v_bfe_u32 v10, v9, 1, 2
    v_lshlrev_b32 v9, 7, v9
    v_lshl_add_u32 v9, v10, 5, v9
    v_and_b32 v10, 3, v1
    v_lshl_add_u32 v9, v10, 3, v9
    s_lshl_b32 s9, s3, 5
    v_xor_b32 v9, s9, v9
    v_add_u32 v9, 65536, v9
    v_add_u32 v10, 65536, v9
    v_mov_b32 v12, 0x3f803f80
    v_mov_b32 v13, 0x3f803f80
    v_mov_b32 v14, 0x3f803f80
    v_mov_b32 v15, 0x3f803f80
    s_waitcnt lgkmcnt(0)
    s_mov_b32 s40, s16
    s_and_b32 s41, s17, 0xffff
    s_mov_b32 s42, 2097152
    s_mov_b32 s43, 0x20000
    s_mov_b32 s44, s18
    s_and_b32 s45, s19, 0xffff
    s_mov_b32 s46, 1572864
    s_mov_b32 s47, 0x20000
    s_and_b32 s9, s6, 7
    s_mul_i32 s9, s9, 24576
    s_lshl_b32 s10, s7, 7
    s_add_u32 s9, s9, s10
    v_lshrrev_b32 v158, 3, v1
    v_and_b32 v157, 7, v1
    v_mul_u32_u24 v156, 3072, v158
    v_lshl_add_u32 v156, v157, 4, v156
    s_cmp_ge_u32 s3, 2
    s_nop 1
    s_cbranch_scc1 K1_PFX
    s_lshl_b32 s10, s3, 10
    s_add_u32 s10, s10, s9
    s_add_u32 s11, s10, 394240
    buffer_load_dwordx4 v[152:155], v156, s[44:47], s11 offen
    s_add_u32 s11, s10, 590848
    buffer_load_dwordx4 v[152:155], v156, s[44:47], s11 offen
    s_add_u32 s11, s10, 787456
    buffer_load_dwordx4 v[152:155], v156, s[44:47], s11 offen
    s_add_u32 s11, s10, 984064
    buffer_load_dwordx4 v[152:155], v156, s[44:47], s11 offen
    s_add_u32 s11, s10, 1180672
    buffer_load_dwordx4 v[152:155], v156, s[44:47], s11 offen
    s_add_u32 s11, s10, 1377280
    buffer_load_dwordx4 v[152:155], v156, s[44:47], s11 offen
    s_branch K1_PFQ
K1_PFX:
    v_lshlrev_b32 v158, 10, v158
    v_lshl_add_u32 v157, v157, 4, v158
    s_lshl_b32 s10, s6, 6
    s_and_b32 s11, s7, 3
    s_lshl_b32 s11, s11, 4
    s_add_u32 s10, s10, s11
    s_lshl_b32 s11, s3, 3
    s_add_u32 s10, s10, s11
    s_sub_u32 s10, s10, 16
    s_lshl_b32 s10, s10, 10
    buffer_load_dwordx4 v[152:155], v157, s[40:43], s10 offen offset:256
    buffer_load_dwordx4 v[152:155], v157, s[40:43], s10 offen offset:384
    buffer_load_dwordx4 v[152:155], v157, s[40:43], s10 offen offset:512
    buffer_load_dwordx4 v[152:155], v157, s[40:43], s10 offen offset:640
    buffer_load_dwordx4 v[152:155], v157, s[40:43], s10 offen offset:768
    buffer_load_dwordx4 v[152:155], v157, s[40:43], s10 offen offset:896
K1_PFQ:
    s_mul_i32 s10, s3, 393216
    s_add_u32 s10, s10, s9
    buffer_load_dwordx4 v[152:155], v156, s[44:47], s10 offen
    s_add_u32 s10, s10, 196608
    buffer_load_dwordx4 v[152:155], v156, s[44:47], s10 offen
    s_add_u32 s40, s36, 14155776
    s_addc_u32 s41, s37, 0
    s_and_b32 s41, s41, 0xffff
    s_mov_b32 s42, 40960
    s_mov_b32 s43, 0x20000
    s_add_u32 s56, s36, 15728640
    s_addc_u32 s57, s37, 0
    s_and_b32 s57, s57, 0xffff
    s_mov_b32 s58, 131072
    s_mov_b32 s59, 0x20000
    v_mov_b32 v144, 0x358637bd
    v_mov_b32 v145, 0x358637bd
    v_mov_b32 v146, 0x3fb8aa3b
    v_mov_b32 v147, 0x3fb8aa3b
    s_mov_b32 s39, 0x358637bd
    s_lshl_b32 s10, s7, 2
    s_add_u32 s10, s10, s3
    s_lshl_b32 s12, s10, 10
    s_lshl_b32 s13, s10, 8
    s_add_u32 s13, s13, 32768
    v_lshlrev_b32 v107, 2, v1
    v_lshlrev_b32 v111, 4, v3
    v_lshl_add_u32 v111, v2, 2, v111
    v_cmp_gt_u32 s[14:15], 4, v2
    v_and_b32 v104, 3, v2
    v_cmp_eq_u32 s[60:61], 1, v104
    v_cmp_eq_u32 s[64:65], 2, v104
    v_cmp_eq_u32 s[66:67], 3, v104
    s_mov_b32 s9, 147456
    v_lshl_add_u32 v108, v3, 4, s9
    v_mov_b32 v104, 163712
    v_mov_b32 v105, 1
    v_mov_b32 v106, 0
    v_lshlrev_b32 v110, 11, v1
    s_lshl_b32 s38, s7, 12
    s_lshl_b32 s62, s7, 8
    s_add_u32 s62, s62, 32768
    s_barrier
    ds_read_b64_tr_b16 v[32:33], v9
    ds_read_b64_tr_b16 v[34:35], v9 offset:2048
    ds_read_b64_tr_b16 v[36:37], v9 offset:8192
    ds_read_b64_tr_b16 v[38:39], v9 offset:10240
    ds_read_b128 v[16:19], v5
    ds_read_b128 v[20:23], v5 offset:2048
    ds_read_b128 v[24:27], v5 offset:4096
    ds_read_b128 v[28:31], v5 offset:6144
    s_waitcnt lgkmcnt(0)
    v_mfma_f32_16x16x32_bf16 v[96:99], v[12:15], v[32:35], 0
    ds_read_b64_tr_b16 v[56:57], v9 offset:4096
    ds_read_b64_tr_b16 v[58:59], v9 offset:6144
    v_mfma_f32_16x16x32_bf16 v[100:103], v[12:15], v[36:39], 0
    ds_read_b64_tr_b16 v[60:61], v9 offset:12288
    ds_read_b64_tr_b16 v[62:63], v9 offset:14336
    v_mfma_f32_16x16x32_bf16 v[64:67], v[16:19], v[32:35], 0
    ds_read_b128 v[40:43], v6
    ds_read_b128 v[44:47], v6 offset:2048
    v_mfma_f32_16x16x32_bf16 v[80:83], v[16:19], v[36:39], 0
    ds_read_b128 v[48:51], v6 offset:4096
    ds_read_b128 v[52:55], v6 offset:6144
    v_mfma_f32_16x16x32_bf16 v[68:71], v[20:23], v[32:35], 0
    v_mfma_f32_16x16x32_bf16 v[84:87], v[20:23], v[36:39], 0
    v_mfma_f32_16x16x32_bf16 v[72:75], v[24:27], v[32:35], 0
    v_mfma_f32_16x16x32_bf16 v[88:91], v[24:27], v[36:39], 0
    v_mfma_f32_16x16x32_bf16 v[76:79], v[28:31], v[32:35], 0
    v_mfma_f32_16x16x32_bf16 v[92:95], v[28:31], v[36:39], 0
    s_waitcnt lgkmcnt(0)
    s_barrier
    v_mfma_f32_16x16x32_bf16 v[96:99], v[12:15], v[56:59], v[96:99]
    ds_read_b64_tr_b16 v[32:33], v9 offset:16384
    ds_read_b64_tr_b16 v[34:35], v9 offset:18432
    v_mfma_f32_16x16x32_bf16 v[100:103], v[12:15], v[60:63], v[100:103]
    ds_read_b64_tr_b16 v[36:37], v9 offset:24576
    ds_read_b64_tr_b16 v[38:39], v9 offset:26624
    v_mfma_f32_16x16x32_bf16 v[64:67], v[40:43], v[56:59], v[64:67]
    ds_read_b128 v[16:19], v5 offset:8192
    ds_read_b128 v[20:23], v5 offset:10240
    v_mfma_f32_16x16x32_bf16 v[80:83], v[40:43], v[60:63], v[80:83]
    ds_read_b128 v[24:27], v5 offset:12288
    ds_read_b128 v[28:31], v5 offset:14336
    v_mfma_f32_16x16x32_bf16 v[68:71], v[44:47], v[56:59], v[68:71]
    v_mfma_f32_16x16x32_bf16 v[84:87], v[44:47], v[60:63], v[84:87]
    v_mfma_f32_16x16x32_bf16 v[72:75], v[48:51], v[56:59], v[72:75]
    v_mfma_f32_16x16x32_bf16 v[88:91], v[48:51], v[60:63], v[88:91]
    v_mfma_f32_16x16x32_bf16 v[76:79], v[52:55], v[56:59], v[76:79]
    v_mfma_f32_16x16x32_bf16 v[92:95], v[52:55], v[60:63], v[92:95]
    s_waitcnt lgkmcnt(0)
    v_mfma_f32_16x16x32_bf16 v[96:99], v[12:15], v[32:35], v[96:99]
    ds_read_b64_tr_b16 v[56:57], v9 offset:20480
    ds_read_b64_tr_b16 v[58:59], v9 offset:22528
    v_mfma_f32_16x16x32_bf16 v[100:103], v[12:15], v[36:39], v[100:103]
    ds_read_b64_tr_b16 v[60:61], v9 offset:28672
    ds_read_b64_tr_b16 v[62:63], v9 offset:30720
    v_mfma_f32_16x16x32_bf16 v[64:67], v[16:19], v[32:35], v[64:67]
    ds_read_b128 v[40:43], v6 offset:8192
    ds_read_b128 v[44:47], v6 offset:10240
    v_mfma_f32_16x16x32_bf16 v[80:83], v[16:19], v[36:39], v[80:83]
    ds_read_b128 v[48:51], v6 offset:12288
    ds_read_b128 v[52:55], v6 offset:14336
    v_mfma_f32_16x16x32_bf16 v[68:71], v[20:23], v[32:35], v[68:71]
    v_mfma_f32_16x16x32_bf16 v[84:87], v[20:23], v[36:39], v[84:87]
    v_mfma_f32_16x16x32_bf16 v[72:75], v[24:27], v[32:35], v[72:75]
    v_mfma_f32_16x16x32_bf16 v[88:91], v[24:27], v[36:39], v[88:91]
    v_mfma_f32_16x16x32_bf16 v[76:79], v[28:31], v[32:35], v[76:79]
    v_mfma_f32_16x16x32_bf16 v[92:95], v[28:31], v[36:39], v[92:95]
    s_waitcnt lgkmcnt(0)
    s_barrier
    v_mfma_f32_16x16x32_bf16 v[96:99], v[12:15], v[56:59], v[96:99]
    ds_read_b64_tr_b16 v[32:33], v9 offset:32768
    ds_read_b64_tr_b16 v[34:35], v9 offset:34816
    v_mfma_f32_16x16x32_bf16 v[100:103], v[12:15], v[60:63], v[100:103]
    ds_read_b64_tr_b16 v[36:37], v9 offset:40960
    ds_read_b64_tr_b16 v[38:39], v9 offset:43008
    v_mfma_f32_16x16x32_bf16 v[64:67], v[40:43], v[56:59], v[64:67]
    ds_read_b128 v[16:19], v5 offset:16384
    ds_read_b128 v[20:23], v5 offset:18432
    v_mfma_f32_16x16x32_bf16 v[80:83], v[40:43], v[60:63], v[80:83]
    ds_read_b128 v[24:27], v5 offset:20480
    ds_read_b128 v[28:31], v5 offset:22528
    v_mfma_f32_16x16x32_bf16 v[68:71], v[44:47], v[56:59], v[68:71]
    v_mfma_f32_16x16x32_bf16 v[84:87], v[44:47], v[60:63], v[84:87]
    v_mfma_f32_16x16x32_bf16 v[72:75], v[48:51], v[56:59], v[72:75]
    v_mfma_f32_16x16x32_bf16 v[88:91], v[48:51], v[60:63], v[88:91]
    v_mfma_f32_16x16x32_bf16 v[76:79], v[52:55], v[56:59], v[76:79]
    v_mfma_f32_16x16x32_bf16 v[92:95], v[52:55], v[60:63], v[92:95]
PGS0:
    s_cbranch_execz PGS1
    s_waitcnt lgkmcnt(0)
    v_mfma_f32_16x16x32_bf16 v[96:99], v[12:15], v[32:35], v[96:99]
    ds_read_b64_tr_b16 v[56:57], v9 offset:36864
    ds_read_b64_tr_b16 v[58:59], v9 offset:38912
    v_mfma_f32_16x16x32_bf16 v[100:103], v[12:15], v[36:39], v[100:103]
    ds_read_b64_tr_b16 v[60:61], v9 offset:45056
    ds_read_b64_tr_b16 v[62:63], v9 offset:47104
    v_mfma_f32_16x16x32_bf16 v[64:67], v[16:19], v[32:35], v[64:67]
    ds_read_b128 v[40:43], v6 offset:16384
    ds_read_b128 v[44:47], v6 offset:18432
    v_mfma_f32_16x16x32_bf16 v[80:83], v[16:19], v[36:39], v[80:83]
    ds_read_b128 v[48:51], v6 offset:20480
    ds_read_b128 v[52:55], v6 offset:22528
    v_mfma_f32_16x16x32_bf16 v[68:71], v[20:23], v[32:35], v[68:71]
    v_mfma_f32_16x16x32_bf16 v[84:87], v[20:23], v[36:39], v[84:87]
    v_mfma_f32_16x16x32_bf16 v[72:75], v[24:27], v[32:35], v[72:75]
    v_mfma_f32_16x16x32_bf16 v[88:91], v[24:27], v[36:39], v[88:91]
    v_mfma_f32_16x16x32_bf16 v[76:79], v[28:31], v[32:35], v[76:79]
    v_mfma_f32_16x16x32_bf16 v[92:95], v[28:31], v[36:39], v[92:95]
    s_waitcnt lgkmcnt(0)
    s_barrier
    v_mfma_f32_16x16x32_bf16 v[96:99], v[12:15], v[56:59], v[96:99]
    ds_read_b64_tr_b16 v[32:33], v9 offset:49152
    ds_read_b64_tr_b16 v[34:35], v9 offset:51200
    v_mfma_f32_16x16x32_bf16 v[100:103], v[12:15], v[60:63], v[100:103]
    ds_read_b64_tr_b16 v[36:37], v9 offset:57344
    ds_read_b64_tr_b16 v[38:39], v9 offset:59392
    v_mfma_f32_16x16x32_bf16 v[64:67], v[40:43], v[56:59], v[64:67]
    ds_read_b128 v[16:19], v5 offset:24576
    ds_read_b128 v[20:23], v5 offset:26624
    v_mfma_f32_16x16x32_bf16 v[80:83], v[40:43], v[60:63], v[80:83]
    ds_read_b128 v[24:27], v5 offset:28672
    ds_read_b128 v[28:31], v5 offset:30720
    v_mfma_f32_16x16x32_bf16 v[68:71], v[44:47], v[56:59], v[68:71]
    v_mfma_f32_16x16x32_bf16 v[84:87], v[44:47], v[60:63], v[84:87]
    v_mfma_f32_16x16x32_bf16 v[72:75], v[48:51], v[56:59], v[72:75]
    v_mfma_f32_16x16x32_bf16 v[88:91], v[48:51], v[60:63], v[88:91]
    v_mfma_f32_16x16x32_bf16 v[76:79], v[52:55], v[56:59], v[76:79]
    v_mfma_f32_16x16x32_bf16 v[92:95], v[52:55], v[60:63], v[92:95]
    s_waitcnt lgkmcnt(0)
    v_mfma_f32_16x16x32_bf16 v[96:99], v[12:15], v[32:35], v[96:99]
    ds_read_b64_tr_b16 v[56:57], v9 offset:53248
    ds_read_b64_tr_b16 v[58:59], v9 offset:55296
    v_mfma_f32_16x16x32_bf16 v[100:103], v[12:15], v[36:39], v[100:103]
    ds_read_b64_tr_b16 v[60:61], v9 offset:61440
    ds_read_b64_tr_b16 v[62:63], v9 offset:63488
    v_mfma_f32_16x16x32_bf16 v[64:67], v[16:19], v[32:35], v[64:67]
    ds_read_b128 v[40:43], v6 offset:24576
    ds_read_b128 v[44:47], v6 offset:26624
    v_mfma_f32_16x16x32_bf16 v[80:83], v[16:19], v[36:39], v[80:83]
    ds_read_b128 v[48:51], v6 offset:28672
    ds_read_b128 v[52:55], v6 offset:30720
    v_mfma_f32_16x16x32_bf16 v[68:71], v[20:23], v[32:35], v[68:71]
    v_mfma_f32_16x16x32_bf16 v[84:87], v[20:23], v[36:39], v[84:87]
    v_mfma_f32_16x16x32_bf16 v[72:75], v[24:27], v[32:35], v[72:75]
    v_mfma_f32_16x16x32_bf16 v[88:91], v[24:27], v[36:39], v[88:91]
    v_mfma_f32_16x16x32_bf16 v[76:79], v[28:31], v[32:35], v[76:79]
    v_mfma_f32_16x16x32_bf16 v[92:95], v[28:31], v[36:39], v[92:95]
    s_waitcnt lgkmcnt(0)
    s_barrier
    v_mfma_f32_16x16x32_bf16 v[96:99], v[12:15], v[56:59], v[96:99]
    ds_read_b64_tr_b16 v[32:33], v10
    ds_read_b64_tr_b16 v[34:35], v10 offset:2048
    v_mfma_f32_16x16x32_bf16 v[100:103], v[12:15], v[60:63], v[100:103]
    ds_read_b64_tr_b16 v[36:37], v10 offset:8192
    ds_read_b64_tr_b16 v[38:39], v10 offset:10240
    v_mfma_f32_16x16x32_bf16 v[64:67], v[40:43], v[56:59], v[64:67]
    ds_read_b128 v[16:19], v5 offset:32768
    ds_read_b128 v[20:23], v5 offset:34816
    v_mfma_f32_16x16x32_bf16 v[80:83], v[40:43], v[60:63], v[80:83]
    ds_read_b128 v[24:27], v5 offset:36864
    ds_read_b128 v[28:31], v5 offset:38912
    v_mfma_f32_16x16x32_bf16 v[68:71], v[44:47], v[56:59], v[68:71]
    v_mfma_f32_16x16x32_bf16 v[84:87], v[44:47], v[60:63], v[84:87]
    v_mfma_f32_16x16x32_bf16 v[72:75], v[48:51], v[56:59], v[72:75]
    v_mfma_f32_16x16x32_bf16 v[88:91], v[48:51], v[60:63], v[88:91]
    v_mfma_f32_16x16x32_bf16 v[76:79], v[52:55], v[56:59], v[76:79]
    v_mfma_f32_16x16x32_bf16 v[92:95], v[52:55], v[60:63], v[92:95]
    s_waitcnt lgkmcnt(0)
    v_mfma_f32_16x16x32_bf16 v[96:99], v[12:15], v[32:35], v[96:99]
    ds_read_b64_tr_b16 v[56:57], v10 offset:4096
    ds_read_b64_tr_b16 v[58:59], v10 offset:6144
    v_mfma_f32_16x16x32_bf16 v[100:103], v[12:15], v[36:39], v[100:103]
    ds_read_b64_tr_b16 v[60:61], v10 offset:12288
    ds_read_b64_tr_b16 v[62:63], v10 offset:14336
    v_mfma_f32_16x16x32_bf16 v[64:67], v[16:19], v[32:35], v[64:67]
    ds_read_b128 v[40:43], v6 offset:32768
    ds_read_b128 v[44:47], v6 offset:34816
    v_mfma_f32_16x16x32_bf16 v[80:83], v[16:19], v[36:39], v[80:83]
    ds_read_b128 v[48:51], v6 offset:36864
    ds_read_b128 v[52:55], v6 offset:38912
    v_mfma_f32_16x16x32_bf16 v[68:71], v[20:23], v[32:35], v[68:71]
    v_mfma_f32_16x16x32_bf16 v[84:87], v[20:23], v[36:39], v[84:87]
    v_mfma_f32_16x16x32_bf16 v[72:75], v[24:27], v[32:35], v[72:75]
    v_mfma_f32_16x16x32_bf16 v[88:91], v[24:27], v[36:39], v[88:91]
    v_mfma_f32_16x16x32_bf16 v[76:79], v[28:31], v[32:35], v[76:79]
    v_mfma_f32_16x16x32_bf16 v[92:95], v[28:31], v[36:39], v[92:95]
    s_waitcnt lgkmcnt(0)
    s_barrier
    v_mfma_f32_16x16x32_bf16 v[96:99], v[12:15], v[56:59], v[96:99]
    ds_read_b64_tr_b16 v[32:33], v9
    ds_read_b64_tr_b16 v[34:35], v9 offset:2048
    v_mfma_f32_16x16x32_bf16 v[100:103], v[12:15], v[60:63], v[100:103]
    ds_read_b64_tr_b16 v[36:37], v9 offset:8192
    ds_read_b64_tr_b16 v[38:39], v9 offset:10240
    v_mfma_f32_16x16x32_bf16 v[64:67], v[40:43], v[56:59], v[64:67]
    ds_read_b128 v[16:19], v5 offset:40960
    ds_read_b128 v[20:23], v5 offset:43008
    v_mfma_f32_16x16x32_bf16 v[80:83], v[40:43], v[60:63], v[80:83]
    ds_read_b128 v[24:27], v5 offset:45056
    ds_read_b128 v[28:31], v5 offset:47104
    v_mfma_f32_16x16x32_bf16 v[68:71], v[44:47], v[56:59], v[68:71]
    v_mfma_f32_16x16x32_bf16 v[84:87], v[44:47], v[60:63], v[84:87]
    v_mfma_f32_16x16x32_bf16 v[72:75], v[48:51], v[56:59], v[72:75]
    v_mfma_f32_16x16x32_bf16 v[88:91], v[48:51], v[60:63], v[88:91]
    v_mfma_f32_16x16x32_bf16 v[76:79], v[52:55], v[56:59], v[76:79]
    v_mfma_f32_16x16x32_bf16 v[92:95], v[52:55], v[60:63], v[92:95]
    s_waitcnt lgkmcnt(0)
    v_mfma_f32_16x16x32_bf16 v[96:99], v[12:15], v[32:35], v[96:99]
    ds_read_b64_tr_b16 v[56:57], v9 offset:4096
    ds_read_b64_tr_b16 v[58:59], v9 offset:6144
    v_mfma_f32_16x16x32_bf16 v[100:103], v[12:15], v[36:39], v[100:103]
    ds_read_b64_tr_b16 v[60:61], v9 offset:12288
    ds_read_b64_tr_b16 v[62:63], v9 offset:14336
    v_mfma_f32_16x16x32_bf16 v[64:67], v[16:19], v[32:35], v[64:67]
    ds_read_b128 v[40:43], v6 offset:40960
    ds_read_b128 v[44:47], v6 offset:43008
    v_mfma_f32_16x16x32_bf16 v[80:83], v[16:19], v[36:39], v[80:83]
    ds_read_b128 v[48:51], v6 offset:45056
    ds_read_b128 v[52:55], v6 offset:47104
    v_mfma_f32_16x16x32_bf16 v[68:71], v[20:23], v[32:35], v[68:71]
    v_mfma_f32_16x16x32_bf16 v[84:87], v[20:23], v[36:39], v[84:87]
    v_mfma_f32_16x16x32_bf16 v[72:75], v[24:27], v[32:35], v[72:75]
    v_mfma_f32_16x16x32_bf16 v[88:91], v[24:27], v[36:39], v[88:91]
    v_mfma_f32_16x16x32_bf16 v[76:79], v[28:31], v[32:35], v[76:79]
    v_mfma_f32_16x16x32_bf16 v[92:95], v[28:31], v[36:39], v[92:95]
    s_waitcnt lgkmcnt(0)
    s_barrier
    v_mfma_f32_16x16x32_bf16 v[96:99], v[12:15], v[56:59], v[96:99]
    ds_read_b64_tr_b16 v[32:33], v9 offset:16384
    ds_read_b64_tr_b16 v[34:35], v9 offset:18432
    v_mfma_f32_16x16x32_bf16 v[100:103], v[12:15], v[60:63], v[100:103]
    ds_read_b64_tr_b16 v[36:37], v9 offset:24576
    ds_read_b64_tr_b16 v[38:39], v9 offset:26624
    v_mfma_f32_16x16x32_bf16 v[64:67], v[40:43], v[56:59], v[64:67]
    ds_read_b128 v[16:19], v5 offset:49152
    ds_read_b128 v[20:23], v5 offset:51200
    v_mfma_f32_16x16x32_bf16 v[80:83], v[40:43], v[60:63], v[80:83]
    ds_read_b128 v[24:27], v5 offset:53248
    ds_read_b128 v[28:31], v5 offset:55296
    v_mfma_f32_16x16x32_bf16 v[68:71], v[44:47], v[56:59], v[68:71]
    v_mfma_f32_16x16x32_bf16 v[84:87], v[44:47], v[60:63], v[84:87]
    v_mfma_f32_16x16x32_bf16 v[72:75], v[48:51], v[56:59], v[72:75]
    v_mfma_f32_16x16x32_bf16 v[88:91], v[48:51], v[60:63], v[88:91]
    v_mfma_f32_16x16x32_bf16 v[76:79], v[52:55], v[56:59], v[76:79]
    v_mfma_f32_16x16x32_bf16 v[92:95], v[52:55], v[60:63], v[92:95]
    s_waitcnt lgkmcnt(0)
    v_mfma_f32_16x16x32_bf16 v[96:99], v[12:15], v[32:35], v[96:99]
    ds_read_b64_tr_b16 v[56:57], v9 offset:20480
    ds_read_b64_tr_b16 v[58:59], v9 offset:22528
    v_mfma_f32_16x16x32_bf16 v[100:103], v[12:15], v[36:39], v[100:103]
    ds_read_b64_tr_b16 v[60:61], v9 offset:28672
    ds_read_b64_tr_b16 v[62:63], v9 offset:30720
    v_mfma_f32_16x16x32_bf16 v[64:67], v[16:19], v[32:35], v[64:67]
    ds_read_b128 v[40:43], v6 offset:49152
    ds_read_b128 v[44:47], v6 offset:51200
    v_mfma_f32_16x16x32_bf16 v[80:83], v[16:19], v[36:39], v[80:83]
    ds_read_b128 v[48:51], v6 offset:53248
    ds_read_b128 v[52:55], v6 offset:55296
    v_mfma_f32_16x16x32_bf16 v[68:71], v[20:23], v[32:35], v[68:71]
    v_mfma_f32_16x16x32_bf16 v[84:87], v[20:23], v[36:39], v[84:87]
    v_mfma_f32_16x16x32_bf16 v[72:75], v[24:27], v[32:35], v[72:75]
    v_mfma_f32_16x16x32_bf16 v[88:91], v[24:27], v[36:39], v[88:91]
    v_mfma_f32_16x16x32_bf16 v[76:79], v[28:31], v[32:35], v[76:79]
    v_mfma_f32_16x16x32_bf16 v[92:95], v[28:31], v[36:39], v[92:95]
    s_waitcnt lgkmcnt(0)
    s_barrier
    v_mfma_f32_16x16x32_bf16 v[96:99], v[12:15], v[56:59], v[96:99]
    ds_read_b64_tr_b16 v[32:33], v9 offset:32768
    ds_read_b64_tr_b16 v[34:35], v9 offset:34816
    v_mfma_f32_16x16x32_bf16 v[100:103], v[12:15], v[60:63], v[100:103]
    ds_read_b64_tr_b16 v[36:37], v9 offset:40960
    ds_read_b64_tr_b16 v[38:39], v9 offset:43008
    v_mfma_f32_16x16x32_bf16 v[64:67], v[40:43], v[56:59], v[64:67]
    ds_read_b128 v[16:19], v5 offset:57344
    ds_read_b128 v[20:23], v5 offset:59392
    v_mfma_f32_16x16x32_bf16 v[80:83], v[40:43], v[60:63], v[80:83]
    ds_read_b128 v[24:27], v5 offset:61440
    ds_read_b128 v[28:31], v5 offset:63488
    v_mfma_f32_16x16x32_bf16 v[68:71], v[44:47], v[56:59], v[68:71]
    v_mfma_f32_16x16x32_bf16 v[84:87], v[44:47], v[60:63], v[84:87]
    v_mfma_f32_16x16x32_bf16 v[72:75], v[48:51], v[56:59], v[72:75]
    v_mfma_f32_16x16x32_bf16 v[88:91], v[48:51], v[60:63], v[88:91]
    v_mfma_f32_16x16x32_bf16 v[76:79], v[52:55], v[56:59], v[76:79]
    v_mfma_f32_16x16x32_bf16 v[92:95], v[52:55], v[60:63], v[92:95]
    s_waitcnt lgkmcnt(0)
    v_mfma_f32_16x16x32_bf16 v[96:99], v[12:15], v[32:35], v[96:99]
    ds_read_b64_tr_b16 v[56:57], v9 offset:36864
    ds_read_b64_tr_b16 v[58:59], v9 offset:38912
    v_mfma_f32_16x16x32_bf16 v[100:103], v[12:15], v[36:39], v[100:103]
    ds_read_b64_tr_b16 v[60:61], v9 offset:45056
    ds_read_b64_tr_b16 v[62:63], v9 offset:47104
    v_mfma_f32_16x16x32_bf16 v[64:67], v[16:19], v[32:35], v[64:67]
    ds_read_b128 v[40:43], v6 offset:57344
    ds_read_b128 v[44:47], v6 offset:59392
    v_mfma_f32_16x16x32_bf16 v[80:83], v[16:19], v[36:39], v[80:83]
    ds_read_b128 v[48:51], v6 offset:61440
    ds_read_b128 v[52:55], v6 offset:63488
    v_mfma_f32_16x16x32_bf16 v[68:71], v[20:23], v[32:35], v[68:71]
    ds_read_b128 v[112:115], v108
    ds_read_b128 v[128:131], v108 offset:256
    v_mfma_f32_16x16x32_bf16 v[84:87], v[20:23], v[36:39], v[84:87]
    ds_read_b128 v[116:119], v108 offset:64
    ds_read_b128 v[132:135], v108 offset:320
    v_mfma_f32_16x16x32_bf16 v[72:75], v[24:27], v[32:35], v[72:75]
    v_mfma_f32_16x16x32_bf16 v[88:91], v[24:27], v[36:39], v[88:91]
    v_mfma_f32_16x16x32_bf16 v[76:79], v[28:31], v[32:35], v[76:79]
    v_mfma_f32_16x16x32_bf16 v[92:95], v[28:31], v[36:39], v[92:95]
    s_waitcnt lgkmcnt(4)
    v_mfma_f32_16x16x32_bf16 v[96:99], v[12:15], v[56:59], v[96:99]
    ds_read_b128 v[120:123], v108 offset:128
    ds_read_b128 v[136:139], v108 offset:384
    v_mfma_f32_16x16x32_bf16 v[100:103], v[12:15], v[60:63], v[100:103]
    ds_read_b128 v[124:127], v108 offset:192
    ds_read_b128 v[140:143], v108 offset:448
    v_mfma_f32_16x16x32_bf16 v[64:67], v[40:43], v[56:59], v[64:67]
    v_mfma_f32_16x16x32_bf16 v[80:83], v[40:43], v[60:63], v[80:83]
    v_mfma_f32_16x16x32_bf16 v[68:71], v[44:47], v[56:59], v[68:71]
    v_mfma_f32_16x16x32_bf16 v[84:87], v[44:47], v[60:63], v[84:87]
    v_mfma_f32_16x16x32_bf16 v[72:75], v[48:51], v[56:59], v[72:75]
    v_mfma_f32_16x16x32_bf16 v[88:91], v[48:51], v[60:63], v[88:91]
    v_mfma_f32_16x16x32_bf16 v[76:79], v[52:55], v[56:59], v[76:79]
    v_mfma_f32_16x16x32_bf16 v[92:95], v[52:55], v[60:63], v[92:95]
    s_waitcnt lgkmcnt(6)
    v_pk_fma_f32 v[64:65], v[112:113], v[96:97], v[64:65] neg_lo:[1,0,0] neg_hi:[1,0,0]
    v_pk_fma_f32 v[66:67], v[114:115], v[96:97], v[66:67] neg_lo:[1,0,0] neg_hi:[1,0,0]
    v_pk_fma_f32 v[80:81], v[112:113], v[100:101], v[80:81] neg_lo:[1,0,0] neg_hi:[1,0,0]
    v_pk_fma_f32 v[82:83], v[114:115], v[100:101], v[82:83] neg_lo:[1,0,0] neg_hi:[1,0,0]
    v_pk_fma_f32 v[64:65], v[64:65], v[128:129], v[144:145]
    v_pk_fma_f32 v[66:67], v[66:67], v[130:131], v[144:145]
    v_pk_mul_f32 v[80:81], v[80:81], v[128:129]
    v_pk_mul_f32 v[82:83], v[82:83], v[130:131]
    v_pk_mul_f32 v[148:149], v[64:65], v[146:147]
    v_pk_mul_f32 v[150:151], v[66:67], v[146:147]
    v_min_f32 v148, 0, v148
    v_min_f32 v149, 0, v149
    v_min_f32 v150, 0, v150
    v_min_f32 v151, 0, v151
    v_exp_f32 v148, v148
    v_exp_f32 v149, v149
    v_exp_f32 v150, v150
    v_exp_f32 v151, v151
    v_max_f32 v64, s39, v64
    v_max_f32 v65, s39, v65
    v_max_f32 v66, s39, v66
    v_max_f32 v67, s39, v67
    v_pk_add_f32 v[64:65], v[64:65], v[148:149]
    v_pk_add_f32 v[66:67], v[66:67], v[150:151]
    v_cvt_pk_bf16_f32 v16, v64, v65
    v_cvt_pk_bf16_f32 v17, v66, v67
    v_cvt_pk_bf16_f32 v24, v80, v81
    v_cvt_pk_bf16_f32 v25, v82, v83
    s_waitcnt lgkmcnt(4)
    v_pk_fma_f32 v[68:69], v[116:117], v[96:97], v[68:69] neg_lo:[1,0,0] neg_hi:[1,0,0]
    v_pk_fma_f32 v[70:71], v[118:119], v[96:97], v[70:71] neg_lo:[1,0,0] neg_hi:[1,0,0]
    v_pk_fma_f32 v[84:85], v[116:117], v[100:101], v[84:85] neg_lo:[1,0,0] neg_hi:[1,0,0]
    v_pk_fma_f32 v[86:87], v[118:119], v[100:101], v[86:87] neg_lo:[1,0,0] neg_hi:[1,0,0]
    v_pk_fma_f32 v[68:69], v[68:69], v[132:133], v[144:145]
    v_pk_fma_f32 v[70:71], v[70:71], v[134:135], v[144:145]
    v_pk_mul_f32 v[84:85], v[84:85], v[132:133]
    v_pk_mul_f32 v[86:87], v[86:87], v[134:135]
    v_pk_mul_f32 v[148:149], v[68:69], v[146:147]
    v_pk_mul_f32 v[150:151], v[70:71], v[146:147]
    v_min_f32 v148, 0, v148
    v_min_f32 v149, 0, v149
    v_min_f32 v150, 0, v150
    v_min_f32 v151, 0, v151
    v_exp_f32 v148, v148
    v_exp_f32 v149, v149
    v_exp_f32 v150, v150
    v_exp_f32 v151, v151
    v_max_f32 v68, s39, v68
    v_max_f32 v69, s39, v69
    v_max_f32 v70, s39, v70
    v_max_f32 v71, s39, v71
    v_pk_add_f32 v[68:69], v[68:69], v[148:149]
    v_pk_add_f32 v[70:71], v[70:71], v[150:151]
    v_cvt_pk_bf16_f32 v18, v68, v69
    v_cvt_pk_bf16_f32 v19, v70, v71
    v_cvt_pk_bf16_f32 v26, v84, v85
    v_cvt_pk_bf16_f32 v27, v86, v87
    s_nop 1
    v_mfma_f32_16x16x32_bf16 v[32:35], v[16:19], v[24:27], 0
    v_mfma_f32_16x16x32_bf16 v[36:39], v[16:19], v[12:15], 0
    s_waitcnt lgkmcnt(2)
    s_waitcnt lgkmcnt(0)
    s_mov_b64 exec, 1
    v_mov_b32 v160, 1
    ds_add_u32 v104, v160 offset:68
    s_mov_b64 exec, -1
    v_pk_fma_f32 v[72:73], v[120:121], v[96:97], v[72:73] neg_lo:[1,0,0] neg_hi:[1,0,0]
    v_pk_fma_f32 v[74:75], v[122:123], v[96:97], v[74:75] neg_lo:[1,0,0] neg_hi:[1,0,0]
    v_pk_fma_f32 v[88:89], v[120:121], v[100:101], v[88:89] neg_lo:[1,0,0] neg_hi:[1,0,0]
    v_pk_fma_f32 v[90:91], v[122:123], v[100:101], v[90:91] neg_lo:[1,0,0] neg_hi:[1,0,0]
    v_pk_fma_f32 v[72:73], v[72:73], v[136:137], v[144:145]
    v_pk_fma_f32 v[74:75], v[74:75], v[138:139], v[144:145]
    v_pk_mul_f32 v[88:89], v[88:89], v[136:137]
    v_pk_mul_f32 v[90:91], v[90:91], v[138:139]
    v_pk_mul_f32 v[148:149], v[72:73], v[146:147]
    v_pk_mul_f32 v[150:151], v[74:75], v[146:147]
    v_min_f32 v148, 0, v148
    v_min_f32 v149, 0, v149
    v_min_f32 v150, 0, v150
    v_min_f32 v151, 0, v151
    v_exp_f32 v148, v148
    v_exp_f32 v149, v149
    v_exp_f32 v150, v150
    v_exp_f32 v151, v151
    v_max_f32 v72, s39, v72
    v_max_f32 v73, s39, v73
    v_max_f32 v74, s39, v74
    v_max_f32 v75, s39, v75
    v_pk_add_f32 v[72:73], v[72:73], v[148:149]
    v_pk_add_f32 v[74:75], v[74:75], v[150:151]
    v_cvt_pk_bf16_f32 v20, v72, v73
    v_cvt_pk_bf16_f32 v21, v74, v75
    v_cvt_pk_bf16_f32 v28, v88, v89
    v_cvt_pk_bf16_f32 v29, v90, v91
    ds_read_b64 v[164:165], v104 offset:8
    v_pk_fma_f32 v[76:77], v[124:125], v[96:97], v[76:77] neg_lo:[1,0,0] neg_hi:[1,0,0]
    v_pk_fma_f32 v[78:79], v[126:127], v[96:97], v[78:79] neg_lo:[1,0,0] neg_hi:[1,0,0]
    v_pk_fma_f32 v[92:93], v[124:125], v[100:101], v[92:93] neg_lo:[1,0,0] neg_hi:[1,0,0]
    v_pk_fma_f32 v[94:95], v[126:127], v[100:101], v[94:95] neg_lo:[1,0,0] neg_hi:[1,0,0]
    v_pk_fma_f32 v[76:77], v[76:77], v[140:141], v[144:145]
    v_pk_fma_f32 v[78:79], v[78:79], v[142:143], v[144:145]
    v_pk_mul_f32 v[92:93], v[92:93], v[140:141]
    v_pk_mul_f32 v[94:95], v[94:95], v[142:143]
    v_pk_mul_f32 v[148:149], v[76:77], v[146:147]
    v_pk_mul_f32 v[150:151], v[78:79], v[146:147]
    v_min_f32 v148, 0, v148
    v_min_f32 v149, 0, v149
    v_min_f32 v150, 0, v150
    v_min_f32 v151, 0, v151
    v_exp_f32 v148, v148
    v_exp_f32 v149, v149
    v_exp_f32 v150, v150
    v_exp_f32 v151, v151
    v_max_f32 v76, s39, v76
    v_max_f32 v77, s39, v77
    v_max_f32 v78, s39, v78
    v_max_f32 v79, s39, v79
    v_pk_add_f32 v[76:77], v[76:77], v[148:149]
    v_pk_add_f32 v[78:79], v[78:79], v[150:151]
    v_cvt_pk_bf16_f32 v22, v76, v77
    v_cvt_pk_bf16_f32 v23, v78, v79
    v_cvt_pk_bf16_f32 v30, v92, v93
    v_cvt_pk_bf16_f32 v31, v94, v95
    s_nop 1
    v_mfma_f32_16x16x32_bf16 v[32:35], v[20:23], v[28:31], v[32:35]
    v_mfma_f32_16x16x32_bf16 v[36:39], v[20:23], v[12:15], v[36:39]
    s_waitcnt lgkmcnt(0)
    v_readfirstlane_b32 s11, v164
    v_readfirstlane_b32 s9, v165
    s_mul_i32 s9, s9, s11
    s_cmp_lg_u32 s9, 0
    s_nop 2
    s_cbranch_scc1 QK_ZWX
QK_ZW:
    ds_read_b64 v[164:165], v104 offset:8
    s_waitcnt lgkmcnt(0)
    v_readfirstlane_b32 s11, v164
    v_readfirstlane_b32 s9, v165
    s_mul_i32 s9, s9, s11
    s_cmp_eq_u32 s9, 0
    s_nop 2
    s_cbranch_scc1 QK_ZW
QK_ZWX:
    s_cmp_lg_u32 s11, 1
    s_cbranch_scc1 QK_NOAT
    buffer_atomic_add_f32 v32, v107, s[40:43], s12 offen
    buffer_atomic_add_f32 v33, v107, s[40:43], s12 offen offset:256
    buffer_atomic_add_f32 v34, v107, s[40:43], s12 offen offset:512
    buffer_atomic_add_f32 v35, v107, s[40:43], s12 offen offset:768
    v_cndmask_b32 v36, v36, v37, s[60:61]
    v_cndmask_b32 v36, v36, v38, s[64:65]
    v_cndmask_b32 v36, v36, v39, s[66:67]
    s_mov_b64 exec, s[14:15]
    buffer_atomic_add_f32 v36, v111, s[40:43], s13 offen
    s_nop 0
QK_NOAT:
    s_mov_b64 exec, 1
    v_mov_b32 v160, 256
    ds_add_u32 v104, v160 offset:68
    s_waitcnt vmcnt(0)
    ds_add_rtn_u32 v161, v104, v105 offset:76
    s_waitcnt lgkmcnt(0)
    v_readfirstlane_b32 s9, v161
    v_mov_b32 v161, 1
    s_cmp_lg_u32 s9, 3
    s_nop 2
    s_cbranch_scc1 QK_NOFL
    s_cmp_lg_u32 s11, 1
    s_cbranch_scc1 QK_NOGO
    buffer_atomic_add v161, v106, s[56:59], s38 offen offset:2432 sc0
    s_waitcnt vmcnt(0)
    v_readfirstlane_b32 s9, v161
    s_cmp_lg_u32 s9, 31
    s_nop 3
    s_cbranch_scc1 QK_NOGO
    s_mov_b64 exec, 0xff
    v_mov_b32 v162, 0x01010101
    buffer_store_dword v162, v110, s[56:59], s62 offen sc1
    s_mov_b64 exec, 1
    s_nop 0
QK_NOGO:
    v_mov_b32 v160, 65536
    ds_add_u32 v104, v160 offset:68
    s_nop 1
QK_NOFL:
    s_mov_b64 exec, -1
QK_QW:
    ds_read2_b32 v[160:161], v104 offset0:17 offset1:18
    s_waitcnt lgkmcnt(0)
    v_readfirstlane_b32 s9, v161
    v_readfirstlane_b32 s11, v160
    s_cmp_eq_u32 s9, 0
    s_nop 3
    s_cbranch_scc1 QK_QW
    s_and_b32 s11, s11, 255
    s_cmp_lg_u32 s11, 8
    s_cbranch_scc1 QK_QW
    s_bfe_u32 s6, s9, 0x80008
    s_bfe_u32 s7, s9, 0x80010
    s_bitcmp1_b32 s9, 0
    s_cbranch_scc1 QK_ENTRY
    s_branch CA_INIT
QS_ENTRY:
    s_lshl_b32 s9, s7, 5
    v_mov_b32 v144, s9
    s_lshl_b32 s60, 1, s6
    v_mov_b32 v145, s60
    s_mov_b32 s62, 99
    s_cmp_lg_u32 s3, 4
    s_nop 0
    s_cbranch_scc1 K1_EL0
    s_waitcnt lgkmcnt(0)
    s_mov_b32 s44, s34
    s_and_b32 s45, s35, 0xffff
    s_mov_b32 s46, 256
    s_mov_b32 s47, 0x20000
    s_mov_b32 s62, 0
    s_mov_b64 exec, 1
    buffer_atomic_or v145, v144, s[44:47], 0 offen sc0
    s_mov_b64 exec, -1
K1_EL0:
    s_sub_u32 s15, s3, 4
    v_and_b32 v7, 7, v2
    v_xor_b32 v7, v7, v3
    v_lshlrev_b32 v5, 7, v2
    v_lshl_add_u32 v5, v7, 4, v5
    v_xor_b32 v6, 64, v5
    v_lshrrev_b32 v7, 2, v2
    v_lshl_add_u32 v9, v3, 2, v7
    v_bfe_u32 v10, v9, 1, 2
    v_lshlrev_b32 v9, 7, v9
    v_lshl_add_u32 v9, v10, 5, v9
    v_and_b32 v10, 3, v1
    v_lshl_add_u32 v9, v10, 3, v9
    s_lshl_b32 s9, s15, 5
    v_xor_b32 v9, s9, v9
    v_add_u32 v9, 65536, v9
    v_add_u32 v10, 65536, v9
    s_lshl_b32 s9, s15, 11
    v_add_u32 v7, s9, v5
    v_add_u32 v8, s9, v6
    v_mov_b32 v12, 0x3f803f80
    v_mov_b32 v13, 0x3f803f80
    v_mov_b32 v14, 0x3f803f80
    v_mov_b32 v15, 0x3f803f80
    v_mov_b32 v140, 0
    v_mov_b32 v141, 0
    v_mov_b32 v142, 0
    v_mov_b32 v143, 0
    v_mov_b32 v146, 1
    v_lshlrev_b32 v147, 11, v1
    v_lshlrev_b32 v150, 7, v1
    s_waitcnt lgkmcnt(0)
    s_mov_b32 s44, s34
    s_and_b32 s45, s35, 0xffff
    s_mov_b32 s46, 256
    s_mov_b32 s47, 0x20000
    s_add_u32 s40, s36, 14155776
    s_addc_u32 s41, s37, 0
    s_and_b32 s41, s41, 0xffff
    s_mov_b32 s42, 40960
    s_mov_b32 s43, 0x20000
    s_add_u32 s56, s36, 15728640
    s_addc_u32 s57, s37, 0
    s_and_b32 s57, s57, 0xffff
    s_mov_b32 s58, 131072
    s_mov_b32 s59, 0x20000
    s_lshr_b32 s8, s2, 3
    s_cmp_lg_u32 s3, 7
    s_cbranch_scc1 K1_NOCP
    s_and_b32 s9, s8, 7
    s_cmp_ge_u32 s9, 5
    s_cbranch_scc1 K1_NOCP
    s_getpc_b64 s[48:49]
K1_PC:
    s_sub_u32 s48, s48, K1_PC-fused_kernel
    s_subb_u32 s49, s49, 0
    s_and_b32 s49, s49, 0xffff
    s_mov_b32 s50, KF_END-fused_kernel
    s_mov_b32 s51, 0x20000
    s_lshl_b32 s9, s9, 13
    buffer_load_dword v151, v150, s[48:51], s9 offen
K1_NOCP:
    s_lshl_b32 s66, s2, 13
    s_cmp_eq_u32 s3, 5
    s_cselect_b32 s48, s24, s28
    s_cselect_b32 s49, s25, s29
    s_mov_b32 s50, 1835008
    s_sub_u32 s67, s2, 224
    s_lshl_b32 s67, s67, 1
    s_add_u32 s67, s67, s15
    s_sub_u32 s67, s67, 1
    s_lshl_b32 s67, s67, 13
    s_cmp_lt_u32 s2, 224
    s_cselect_b32 s48, s48, s20
    s_cselect_b32 s49, s49, s21
    s_cselect_b32 s50, s50, 524288
    s_cselect_b32 s66, s66, s67
    s_cselect_b32 s63, 0, 6
    s_cselect_b32 s69, 5, 0
    s_and_b32 s49, s49, 0xffff
    s_mov_b32 s51, 0x20000
    s_mov_b32 s52, s20
    s_and_b32 s53, s21, 0xffff
    s_mov_b32 s54, 524288
    s_mov_b32 s55, 0x20000
    s_lshl_b32 s67, s15, 18
    s_lshl_b32 s68, s8, 13
    s_add_u32 s67, s67, s68
    s_sub_u32 s67, s67, 262144
    v_mov_b32 v111, 163712
    s_cmp_lg_u32 s62, 0
    s_nop 1
    s_cbranch_scc1 K1_CPB0
    s_mov_b32 s9, 20
K1_PK:
    s_sleep 1
    v_readfirstlane_b32 s61, v145
    s_sub_u32 s9, s9, 1
    s_cmp_eq_u32 s9, 0
    s_nop 2
    s_cbranch_scc1 K1_PKX
    s_cmp_eq_u32 s61, s60
    s_cbranch_scc1 K1_PK
K1_PKX:
    s_cmp_lg_u32 s61, 0
    s_cbranch_scc1 K1_CPB0
    s_lshl_b32 s61, s7, 12
    buffer_store_dwordx4 v[140:143], v4, s[40:43], s61 offen sc1
    buffer_store_dwordx4 v[140:143], v4, s[40:43], s61 offen offset:1024 sc1
    buffer_store_dwordx4 v[140:143], v4, s[40:43], s61 offen offset:2048 sc1
    buffer_store_dwordx4 v[140:143], v4, s[40:43], s61 offen offset:3072 sc1
    buffer_store_dwordx4 v[140:143], v4, s[56:59], s61 offen sc1
    buffer_store_dwordx4 v[140:143], v4, s[56:59], s61 offen offset:1024 sc1
    buffer_store_dwordx4 v[140:143], v4, s[56:59], s61 offen offset:2048 sc1
    s_nop 0
    s_lshl_b32 s61, s7, 10
    s_add_u32 s61, s61, 32768
    buffer_store_dwordx4 v[140:143], v4, s[40:43], s61 offen sc1
    s_nop 0
    s_lshl_b32 s61, s7, 8
    s_add_u32 s61, s61, 32768
    s_mov_b32 exec_lo, 0xffff00ff
    s_mov_b32 exec_hi, 0xffff
    buffer_store_dword v140, v147, s[56:59], s61 offen sc1
    s_mov_b64 exec, -1
    s_mov_b32 s62, 1
K1_CPB0:
    s_cmp_lg_u32 s3, 6
    s_cbranch_scc1 QS_NOPG
    s_mov_b64 exec, 0
    s_branch PGS0
CH_K1P_RET:
    s_mov_b64 exec, -1
QS_NOPG:
    v_and_b32 v104, 3, v2
    v_cmp_eq_u32 s[10:11], 1, v104
    v_cmp_eq_u32 s[12:13], 2, v104
    v_cmp_eq_u32 vcc, 3, v104
    v_lshrrev_b32 v105, 2, v2
    v_cmp_eq_u32 s[64:65], v105, v3
    s_lshl_b32 s9, s15, 6
    s_add_u32 s9, s9, 147456
    v_lshl_add_u32 v108, v2, 2, s9
    s_lshl_b32 s9, s15, 7
    s_add_u32 s9, s9, 147968
    v_lshl_add_u32 v109, v2, 3, s9
    s_barrier
    ds_read_b128 v[16:19], v7
    ds_read_b128 v[36:39], v8
    s_cmp_lg_u32 s3, 5
    s_cbranch_scc1 QS_NZ
    v_add_u32 v104, 163712, v4
    s_mov_b64 exec, 0xff
    ds_write_b128 v104, v[140:143]
    s_mov_b64 exec, -1
QS_NZ:
    s_cmp_lg_u32 s62, 1
    s_cbranch_scc1 K1_CPA0
    s_waitcnt vmcnt(0)
    s_mov_b64 exec, 1
    buffer_store_dword v146, v144, s[44:47], 0 offen offset:4 sc1
    s_mov_b64 exec, -1
    s_mov_b32 s62, 99
K1_CPA0:
    s_cmp_lg_u32 s62, 0
    s_cbranch_scc1 K1_CPB1
    v_readfirstlane_b32 s61, v145
    s_cmp_lg_u32 s61, 0
    s_nop 3
    s_cbranch_scc1 K1_CPB1
    s_lshl_b32 s61, s7, 12
    buffer_store_dwordx4 v[140:143], v4, s[40:43], s61 offen sc1
    buffer_store_dwordx4 v[140:143], v4, s[40:43], s61 offen offset:1024 sc1
    buffer_store_dwordx4 v[140:143], v4, s[40:43], s61 offen offset:2048 sc1
    buffer_store_dwordx4 v[140:143], v4, s[40:43], s61 offen offset:3072 sc1
    buffer_store_dwordx4 v[140:143], v4, s[56:59], s61 offen sc1
    buffer_store_dwordx4 v[140:143], v4, s[56:59], s61 offen offset:1024 sc1
    buffer_store_dwordx4 v[140:143], v4, s[56:59], s61 offen offset:2048 sc1
    s_nop 0
    s_lshl_b32 s61, s7, 10
    s_add_u32 s61, s61, 32768
    buffer_store_dwordx4 v[140:143], v4, s[40:43], s61 offen sc1
    s_nop 0
    s_lshl_b32 s61, s7, 8
    s_add_u32 s61, s61, 32768
    s_mov_b32 exec_lo, 0xffff00ff
    s_mov_b32 exec_hi, 0xffff
    buffer_store_dword v140, v147, s[56:59], s61 offen sc1
    s_mov_b64 exec, -1
    s_mov_b32 s62, 2
K1_CPB1:
    s_waitcnt lgkmcnt(0)
    v_mfma_f32_16x16x32_bf16 v[76:79], v[16:19], v[12:15], 0
PGS1:
    s_cbranch_execz CH_K1P_RET
    v_mfma_f32_16x16x32_bf16 v[80:83], v[16:19], v[16:19], 0
    v_mfma_f32_16x16x32_bf16 v[76:79], v[36:39], v[12:15], v[76:79]
    v_mfma_f32_16x16x32_bf16 v[80:83], v[36:39], v[36:39], v[80:83]
    s_barrier
    ds_read_b128 v[16:19], v7 offset:8192
    ds_read_b128 v[36:39], v8 offset:8192
    s_cmp_lg_u32 s62, 2
    s_nop 3
    s_cbranch_scc1 K1_CPA1
    s_waitcnt vmcnt(0)
    s_mov_b64 exec, 1
    buffer_store_dword v146, v144, s[44:47], 0 offen offset:4 sc1
    s_mov_b64 exec, -1
    s_mov_b32 s62, 99
K1_CPA1:
    s_waitcnt lgkmcnt(0)
    v_mfma_f32_16x16x32_bf16 v[76:79], v[16:19], v[12:15], v[76:79]
    v_mfma_f32_16x16x32_bf16 v[80:83], v[16:19], v[16:19], v[80:83]
    v_mfma_f32_16x16x32_bf16 v[76:79], v[36:39], v[12:15], v[76:79]
    v_mfma_f32_16x16x32_bf16 v[80:83], v[36:39], v[36:39], v[80:83]
    s_barrier
    ds_read_b128 v[16:19], v7 offset:16384
    ds_read_b128 v[36:39], v8 offset:16384
    ds_read_b128 v[20:23], v7 offset:24576
    ds_read_b128 v[40:43], v8 offset:24576
    s_cmp_lg_u32 s62, 0
    s_nop 1
    s_cbranch_scc1 K1_CPB3
    v_readfirstlane_b32 s61, v145
    s_cmp_lg_u32 s61, 0
    s_nop 3
    s_cbranch_scc1 K1_CPB3
    s_lshl_b32 s61, s7, 12
    buffer_store_dwordx4 v[140:143], v4, s[40:43], s61 offen sc1
    buffer_store_dwordx4 v[140:143], v4, s[40:43], s61 offen offset:1024 sc1
    buffer_store_dwordx4 v[140:143], v4, s[40:43], s61 offen offset:2048 sc1
    buffer_store_dwordx4 v[140:143], v4, s[40:43], s61 offen offset:3072 sc1
    buffer_store_dwordx4 v[140:143], v4, s[56:59], s61 offen sc1
    buffer_store_dwordx4 v[140:143], v4, s[56:59], s61 offen offset:1024 sc1
    buffer_store_dwordx4 v[140:143], v4, s[56:59], s61 offen offset:2048 sc1
    s_nop 0
    s_lshl_b32 s61, s7, 10
    s_add_u32 s61, s61, 32768
    buffer_store_dwordx4 v[140:143], v4, s[40:43], s61 offen sc1
    s_nop 0
    s_lshl_b32 s61, s7, 8
    s_add_u32 s61, s61, 32768
    s_mov_b32 exec_lo, 0xffff00ff
    s_mov_b32 exec_hi, 0xffff
    buffer_store_dword v140, v147, s[56:59], s61 offen sc1
    s_mov_b64 exec, -1
    s_mov_b32 s62, 4
K1_CPB3:
    s_waitcnt lgkmcnt(0)
    v_mfma_f32_16x16x32_bf16 v[76:79], v[16:19], v[12:15], v[76:79]
    v_mfma_f32_16x16x32_bf16 v[80:83], v[16:19], v[16:19], v[80:83]
    v_mfma_f32_16x16x32_bf16 v[76:79], v[36:39], v[12:15], v[76:79]
    v_mfma_f32_16x16x32_bf16 v[80:83], v[36:39], v[36:39], v[80:83]
    v_mfma_f32_16x16x32_bf16 v[76:79], v[20:23], v[12:15], v[76:79]
    v_mfma_f32_16x16x32_bf16 v[80:83], v[20:23], v[20:23], v[80:83]
    v_mfma_f32_16x16x32_bf16 v[76:79], v[40:43], v[12:15], v[76:79]
    v_mfma_f32_16x16x32_bf16 v[80:83], v[40:43], v[40:43], v[80:83]
    s_barrier
    ds_read_b128 v[16:19], v7 offset:32768
    ds_read_b128 v[36:39], v8 offset:32768
    ds_read_b128 v[20:23], v7 offset:40960
    ds_read_b128 v[40:43], v8 offset:40960
    s_cmp_lg_u32 s62, 4
    s_nop 1
    s_cbranch_scc1 K1_CPA3
    s_waitcnt vmcnt(0)
    s_mov_b64 exec, 1
    buffer_store_dword v146, v144, s[44:47], 0 offen offset:4 sc1
    s_mov_b64 exec, -1
    s_mov_b32 s62, 99
K1_CPA3:
    s_waitcnt lgkmcnt(0)
    v_mfma_f32_16x16x32_bf16 v[76:79], v[16:19], v[12:15], v[76:79]
    v_mfma_f32_16x16x32_bf16 v[80:83], v[16:19], v[16:19], v[80:83]
    v_mfma_f32_16x16x32_bf16 v[76:79], v[36:39], v[12:15], v[76:79]
    v_mfma_f32_16x16x32_bf16 v[80:83], v[36:39], v[36:39], v[80:83]
    v_mfma_f32_16x16x32_bf16 v[76:79], v[20:23], v[12:15], v[76:79]
    v_mfma_f32_16x16x32_bf16 v[80:83], v[20:23], v[20:23], v[80:83]
    v_mfma_f32_16x16x32_bf16 v[76:79], v[40:43], v[12:15], v[76:79]
    v_mfma_f32_16x16x32_bf16 v[80:83], v[40:43], v[40:43], v[80:83]
    s_barrier
    ds_read_b128 v[16:19], v7 offset:49152
    ds_read_b128 v[36:39], v8 offset:49152
    ds_read_b128 v[20:23], v7 offset:57344
    ds_read_b128 v[40:43], v8 offset:57344
    s_waitcnt lgkmcnt(0)
    v_mfma_f32_16x16x32_bf16 v[76:79], v[16:19], v[12:15], v[76:79]
    v_mfma_f32_16x16x32_bf16 v[80:83], v[16:19], v[16:19], v[80:83]
    v_mfma_f32_16x16x32_bf16 v[76:79], v[36:39], v[12:15], v[76:79]
    v_mfma_f32_16x16x32_bf16 v[80:83], v[36:39], v[36:39], v[80:83]
    v_mfma_f32_16x16x32_bf16 v[76:79], v[20:23], v[12:15], v[76:79]
    v_mfma_f32_16x16x32_bf16 v[80:83], v[20:23], v[20:23], v[80:83]
    v_mfma_f32_16x16x32_bf16 v[76:79], v[40:43], v[12:15], v[76:79]
    v_mfma_f32_16x16x32_bf16 v[80:83], v[40:43], v[40:43], v[80:83]
    s_barrier
    s_cmp_lg_u32 s3, 5
    s_nop 5
    s_cbranch_scc1 K1_TW0
    buffer_load_dword v151, v150, s[52:55], s67 offen
K1_TW0:
    s_waitcnt lgkmcnt(0)
    v_cndmask_b32 v76, v76, v77, s[10:11]
    v_cndmask_b32 v76, v76, v78, s[12:13]
    v_cndmask_b32 v76, v76, v79, vcc
    v_cndmask_b32 v80, v80, v81, s[10:11]
    v_cndmask_b32 v80, v80, v82, s[12:13]
    v_cndmask_b32 v80, v80, v83, vcc
    v_mov_b32 v77, v80
    v_mul_f32 v106, 0x3b000000, v76
    v_mul_f32 v107, 0x3b000000, v77
    v_fma_f32 v107, -v106, v106, v107
    v_max_f32 v107, 0, v107
    v_cvt_pk_bf16_f32 v76, v106, v107
    v_and_b32 v77, 0xffff0000, v76
    v_lshlrev_b32 v76, 16, v76
    v_add_f32 v77, 0x3727c5ac, v77
    v_cvt_pk_bf16_f32 v77, v77, v77
    v_lshlrev_b32 v77, 16, v77
    v_sqrt_f32 v77, v77
    s_nop 0
    v_cvt_pk_bf16_f32 v77, v77, v77
    v_lshlrev_b32 v77, 16, v77
    v_rcp_f32 v77, v77
    s_mov_b64 exec, s[64:65]
    ds_write_b32 v108, v76
    ds_write_b32 v108, v77 offset:256
    ds_write_b64 v109, v[76:77]
    s_mov_b64 exec, -1
    s_barrier
    s_cmp_lg_u32 s3, 6
    s_cbranch_scc1 K1_TW1
    buffer_load_dword v151, v150, s[52:55], s67 offen
K1_TW1:
    s_waitcnt lgkmcnt(0)
    s_waitcnt lgkmcnt(0)
    s_barrier
    s_mov_b32 s9, 147456
    v_lshl_add_u32 v109, v2, 3, s9
    ds_read_b64 v[112:113], v109 offset:512
    ds_read_b64 v[114:115], v109 offset:640
    ds_read_b64 v[116:117], v109 offset:768
    ds_read_b64 v[118:119], v109 offset:896
    s_cmp_lg_u32 s3, s69
    s_cbranch_scc1 K1_TC0
    buffer_load_dword v151, v150, s[48:51], s66 offen
K1_TC0:
    v_mov_b32 v120, 0x358637bd
    v_mov_b32 v121, 0x358637bd
    v_mov_b32 v122, 0x3fb8aa3b
    v_mov_b32 v123, 0x3fb8aa3b
    s_mov_b32 s39, 0x358637bd
    s_lshl_b32 s13, s6, 5
    s_lshl_b32 s9, s7, 2
    s_add_u32 s13, s13, s9
    s_add_u32 s13, s13, s15
    s_lshl_b32 s13, s13, 11
    s_lshl_b32 s12, s6, 11
    s_lshl_b32 s11, s7, 8
    s_add_u32 s12, s12, s11
    s_add_u32 s12, s12, s15
    s_add_u32 s12, s12, 65536
    s_mov_b32 s38, 0
    s_waitcnt lgkmcnt(0)
    s_cmp_lg_u32 s3, 4
    s_cbranch_scc1 K1_RES2
    s_cmp_eq_u32 s62, 99
    s_cbranch_scc1 K1_RES1
    s_waitcnt vmcnt(0)
    s_cmp_lg_u32 s62, 0
    s_cbranch_scc1 K1_RES0
    v_readfirstlane_b32 s61, v145
    s_cmp_lg_u32 s61, 0
    s_nop 3
    s_cbranch_scc1 K1_RES1
    s_lshl_b32 s61, s7, 12
    buffer_store_dwordx4 v[140:143], v4, s[40:43], s61 offen sc1
    buffer_store_dwordx4 v[140:143], v4, s[40:43], s61 offen offset:1024 sc1
    buffer_store_dwordx4 v[140:143], v4, s[40:43], s61 offen offset:2048 sc1
    buffer_store_dwordx4 v[140:143], v4, s[40:43], s61 offen offset:3072 sc1
    buffer_store_dwordx4 v[140:143], v4, s[56:59], s61 offen sc1
    buffer_store_dwordx4 v[140:143], v4, s[56:59], s61 offen offset:1024 sc1
    buffer_store_dwordx4 v[140:143], v4, s[56:59], s61 offen offset:2048 sc1
    s_nop 0
    s_lshl_b32 s61, s7, 10
    s_add_u32 s61, s61, 32768
    buffer_store_dwordx4 v[140:143], v4, s[40:43], s61 offen sc1
    s_nop 0
    s_lshl_b32 s61, s7, 8
    s_add_u32 s61, s61, 32768
    s_mov_b32 exec_lo, 0xffff00ff
    s_mov_b32 exec_hi, 0xffff
    buffer_store_dword v140, v147, s[56:59], s61 offen sc1
    s_mov_b64 exec, -1
K1_RES0:
    s_waitcnt vmcnt(0)
    s_mov_b64 exec, 1
    buffer_store_dword v146, v144, s[44:47], 0 offen offset:4 sc1
    s_mov_b64 exec, -1
K1_RES1:
    v_and_b32 v104, s60, v145
    v_cmp_eq_u32 vcc, 0, v104
    s_nop 1
    v_cndmask_b32 v104, 2, 1, vcc
    s_mov_b64 exec, 1
    ds_write_b32 v111, v104 offset:8
    s_mov_b64 exec, -1
    s_waitcnt lgkmcnt(0)
K1_RES2:
    s_mov_b32 s40, s36
    s_and_b32 s41, s37, 0xffff
    s_mov_b32 s42, 2097152
    s_mov_b32 s43, 0x20000
    ds_read_b128 v[16:19], v5
    ds_read_b128 v[20:23], v5 offset:2048
    ds_read_b128 v[24:27], v5 offset:4096
    ds_read_b128 v[28:31], v5 offset:6144
    s_bitcmp1_b32 s38, 0
    s_cbranch_scc1 QS_OK0
QS_SP0:
    ds_read_b32 v136, v111
    s_waitcnt lgkmcnt(0)
    v_readfirstlane_b32 s38, v136
    s_bitcmp0_b32 s38, 0
    s_cbranch_scc1 QS_SP0
QS_OK0:
    ds_read_b64_tr_b16 v[32:33], v9 offset:49152
    ds_read_b64_tr_b16 v[34:35], v9 offset:51200
    ds_read_b128 v[36:39], v6
    ds_read_b128 v[40:43], v6 offset:2048
    ds_read_b128 v[44:47], v6 offset:4096
    ds_read_b128 v[48:51], v6 offset:6144
    s_bitcmp1_b32 s38, 1
    s_cbranch_scc1 QS_OK1
QS_SP1:
    ds_read_b32 v136, v111
    s_waitcnt lgkmcnt(0)
    v_readfirstlane_b32 s38, v136
    s_bitcmp0_b32 s38, 1
    s_cbranch_scc1 QS_SP1
QS_OK1:
    ds_read_b64_tr_b16 v[52:53], v9 offset:53248
    ds_read_b64_tr_b16 v[54:55], v9 offset:55296
    s_waitcnt lgkmcnt(6)
    v_mfma_f32_16x16x32_bf16 v[100:103], v[32:35], v[12:15], 0
    ds_read_b128 v[56:59], v5 offset:8192
    ds_read_b128 v[60:63], v5 offset:10240
    v_mfma_f32_16x16x32_bf16 v[84:87], v[32:35], v[16:19], 0
    ds_read_b128 v[64:67], v5 offset:12288
    ds_read_b128 v[68:71], v5 offset:14336
    v_mfma_f32_16x16x32_bf16 v[88:91], v[32:35], v[20:23], 0
    s_bitcmp1_b32 s38, 2
    s_cbranch_scc1 QS_OK2
QS_SP2:
    ds_read_b32 v136, v111
    s_waitcnt lgkmcnt(0)
    v_readfirstlane_b32 s38, v136
    s_bitcmp0_b32 s38, 2
    s_cbranch_scc1 QS_SP2
QS_OK2:
    ds_read_b64_tr_b16 v[72:73], v9 offset:57344
    v_mfma_f32_16x16x32_bf16 v[92:95], v[32:35], v[24:27], 0
    ds_read_b64_tr_b16 v[74:75], v9 offset:59392
    v_mfma_f32_16x16x32_bf16 v[96:99], v[32:35], v[28:31], 0
    s_waitcnt lgkmcnt(6)
    v_mfma_f32_16x16x32_bf16 v[100:103], v[52:55], v[12:15], v[100:103]
    ds_read_b128 v[16:19], v6 offset:8192
    ds_read_b128 v[20:23], v6 offset:10240
    v_mfma_f32_16x16x32_bf16 v[84:87], v[52:55], v[36:39], v[84:87]
    ds_read_b128 v[24:27], v6 offset:12288
    ds_read_b128 v[28:31], v6 offset:14336
    v_mfma_f32_16x16x32_bf16 v[88:91], v[52:55], v[40:43], v[88:91]
    s_bitcmp1_b32 s38, 3
    s_cbranch_scc1 QS_OK3
QS_SP3:
    ds_read_b32 v136, v111
    s_waitcnt lgkmcnt(0)
    v_readfirstlane_b32 s38, v136
    s_bitcmp0_b32 s38, 3
    s_cbranch_scc1 QS_SP3
QS_OK3:
    ds_read_b64_tr_b16 v[32:33], v9 offset:61440
    v_mfma_f32_16x16x32_bf16 v[92:95], v[52:55], v[44:47], v[92:95]
    ds_read_b64_tr_b16 v[34:35], v9 offset:63488
    v_mfma_f32_16x16x32_bf16 v[96:99], v[52:55], v[48:51], v[96:99]
    s_waitcnt lgkmcnt(6)
    v_mfma_f32_16x16x32_bf16 v[100:103], v[72:75], v[12:15], v[100:103]
    ds_read_b128 v[36:39], v5 offset:16384
    ds_read_b128 v[40:43], v5 offset:18432
    v_mfma_f32_16x16x32_bf16 v[84:87], v[72:75], v[56:59], v[84:87]
    ds_read_b128 v[44:47], v5 offset:20480
    ds_read_b128 v[48:51], v5 offset:22528
    v_mfma_f32_16x16x32_bf16 v[88:91], v[72:75], v[60:63], v[88:91]
    s_bitcmp1_b32 s38, 4
    s_cbranch_scc1 QS_OK4
QS_SP4:
    ds_read_b32 v136, v111
    s_waitcnt lgkmcnt(0)
    v_readfirstlane_b32 s38, v136
    s_bitcmp0_b32 s38, 4
    s_cbranch_scc1 QS_SP4
QS_OK4:
    ds_read_b64_tr_b16 v[52:53], v10
    v_mfma_f32_16x16x32_bf16 v[92:95], v[72:75], v[64:67], v[92:95]
    ds_read_b64_tr_b16 v[54:55], v10 offset:2048
    v_mfma_f32_16x16x32_bf16 v[96:99], v[72:75], v[68:71], v[96:99]
    s_waitcnt lgkmcnt(6)
    v_mfma_f32_16x16x32_bf16 v[100:103], v[32:35], v[12:15], v[100:103]
    ds_read_b128 v[56:59], v6 offset:16384
    ds_read_b128 v[60:63], v6 offset:18432
    v_mfma_f32_16x16x32_bf16 v[84:87], v[32:35], v[16:19], v[84:87]
    ds_read_b128 v[64:67], v6 offset:20480
    ds_read_b128 v[68:71], v6 offset:22528
    v_mfma_f32_16x16x32_bf16 v[88:91], v[32:35], v[20:23], v[88:91]
    s_bitcmp1_b32 s38, 5
    s_cbranch_scc1 QS_OK5
QS_SP5:
    ds_read_b32 v136, v111
    s_waitcnt lgkmcnt(0)
    v_readfirstlane_b32 s38, v136
    s_bitcmp0_b32 s38, 5
    s_cbranch_scc1 QS_SP5
QS_OK5:
    ds_read_b64_tr_b16 v[72:73], v10 offset:4096
    v_mfma_f32_16x16x32_bf16 v[92:95], v[32:35], v[24:27], v[92:95]
    ds_read_b64_tr_b16 v[74:75], v10 offset:6144
    v_mfma_f32_16x16x32_bf16 v[96:99], v[32:35], v[28:31], v[96:99]
    s_waitcnt lgkmcnt(6)
    v_mfma_f32_16x16x32_bf16 v[100:103], v[52:55], v[12:15], v[100:103]
    ds_read_b128 v[16:19], v5 offset:24576
    ds_read_b128 v[20:23], v5 offset:26624
    v_mfma_f32_16x16x32_bf16 v[84:87], v[52:55], v[36:39], v[84:87]
    ds_read_b128 v[24:27], v5 offset:28672
    ds_read_b128 v[28:31], v5 offset:30720
    v_mfma_f32_16x16x32_bf16 v[88:91], v[52:55], v[40:43], v[88:91]
    s_bitcmp1_b32 s38, 6
    s_cbranch_scc1 QS_OK6
QS_SP6:
    ds_read_b32 v136, v111
    s_waitcnt lgkmcnt(0)
    v_readfirstlane_b32 s38, v136
    s_bitcmp0_b32 s38, 6
    s_cbranch_scc1 QS_SP6
QS_OK6:
    ds_read_b64_tr_b16 v[32:33], v10 offset:8192
    v_mfma_f32_16x16x32_bf16 v[92:95], v[52:55], v[44:47], v[92:95]
    ds_read_b64_tr_b16 v[34:35], v10 offset:10240
    v_mfma_f32_16x16x32_bf16 v[96:99], v[52:55], v[48:51], v[96:99]
    s_waitcnt lgkmcnt(6)
    v_mfma_f32_16x16x32_bf16 v[100:103], v[72:75], v[12:15], v[100:103]
    ds_read_b128 v[36:39], v6 offset:24576
    ds_read_b128 v[40:43], v6 offset:26624
    v_mfma_f32_16x16x32_bf16 v[84:87], v[72:75], v[56:59], v[84:87]
    ds_read_b128 v[44:47], v6 offset:28672
    ds_read_b128 v[48:51], v6 offset:30720
    v_mfma_f32_16x16x32_bf16 v[88:91], v[72:75], v[60:63], v[88:91]
    s_bitcmp1_b32 s38, 7
    s_cbranch_scc1 QS_OK7
QS_SP7:
    ds_read_b32 v136, v111
    s_waitcnt lgkmcnt(0)
    v_readfirstlane_b32 s38, v136
    s_bitcmp0_b32 s38, 7
    s_cbranch_scc1 QS_SP7
QS_OK7:
    ds_read_b64_tr_b16 v[52:53], v10 offset:12288
    v_mfma_f32_16x16x32_bf16 v[92:95], v[72:75], v[64:67], v[92:95]
    ds_read_b64_tr_b16 v[54:55], v10 offset:14336
    v_mfma_f32_16x16x32_bf16 v[96:99], v[72:75], v[68:71], v[96:99]
    s_waitcnt lgkmcnt(6)
    v_mfma_f32_16x16x32_bf16 v[100:103], v[32:35], v[12:15], v[100:103]
    ds_read_b128 v[56:59], v5 offset:32768
    ds_read_b128 v[60:63], v5 offset:34816
    v_mfma_f32_16x16x32_bf16 v[84:87], v[32:35], v[16:19], v[84:87]
    ds_read_b128 v[64:67], v5 offset:36864
    ds_read_b128 v[68:71], v5 offset:38912
    v_mfma_f32_16x16x32_bf16 v[88:91], v[32:35], v[20:23], v[88:91]
    s_bitcmp1_b32 s38, 8
    s_cbranch_scc1 QS_OK8
QS_SP8:
    ds_read_b32 v136, v111
    s_waitcnt lgkmcnt(0)
    v_readfirstlane_b32 s38, v136
    s_bitcmp0_b32 s38, 8
    s_cbranch_scc1 QS_SP8
QS_OK8:
    ds_read_b64_tr_b16 v[72:73], v9
    v_mfma_f32_16x16x32_bf16 v[92:95], v[32:35], v[24:27], v[92:95]
    ds_read_b64_tr_b16 v[74:75], v9 offset:2048
    v_mfma_f32_16x16x32_bf16 v[96:99], v[32:35], v[28:31], v[96:99]
    s_waitcnt lgkmcnt(6)
    v_mfma_f32_16x16x32_bf16 v[100:103], v[52:55], v[12:15], v[100:103]
    ds_read_b128 v[16:19], v6 offset:32768
    ds_read_b128 v[20:23], v6 offset:34816
    v_mfma_f32_16x16x32_bf16 v[84:87], v[52:55], v[36:39], v[84:87]
    ds_read_b128 v[24:27], v6 offset:36864
    ds_read_b128 v[28:31], v6 offset:38912
    v_mfma_f32_16x16x32_bf16 v[88:91], v[52:55], v[40:43], v[88:91]
    s_bitcmp1_b32 s38, 9
    s_cbranch_scc1 QS_OK9
QS_SP9:
    ds_read_b32 v136, v111
    s_waitcnt lgkmcnt(0)
    v_readfirstlane_b32 s38, v136
    s_bitcmp0_b32 s38, 9
    s_cbranch_scc1 QS_SP9
QS_OK9:
    ds_read_b64_tr_b16 v[32:33], v9 offset:4096
    v_mfma_f32_16x16x32_bf16 v[92:95], v[52:55], v[44:47], v[92:95]
    ds_read_b64_tr_b16 v[34:35], v9 offset:6144
    v_mfma_f32_16x16x32_bf16 v[96:99], v[52:55], v[48:51], v[96:99]
    s_waitcnt lgkmcnt(6)
    v_mfma_f32_16x16x32_bf16 v[100:103], v[72:75], v[12:15], v[100:103]
    ds_read_b128 v[36:39], v5 offset:40960
    ds_read_b128 v[40:43], v5 offset:43008
    v_mfma_f32_16x16x32_bf16 v[84:87], v[72:75], v[56:59], v[84:87]
    ds_read_b128 v[44:47], v5 offset:45056
    ds_read_b128 v[48:51], v5 offset:47104
    v_mfma_f32_16x16x32_bf16 v[88:91], v[72:75], v[60:63], v[88:91]
    s_bitcmp1_b32 s38, 10
    s_cbranch_scc1 QS_OK10
QS_SP10:
    ds_read_b32 v136, v111
    s_waitcnt lgkmcnt(0)
    v_readfirstlane_b32 s38, v136
    s_bitcmp0_b32 s38, 10
    s_cbranch_scc1 QS_SP10
QS_OK10:
    ds_read_b64_tr_b16 v[52:53], v9 offset:8192
    v_mfma_f32_16x16x32_bf16 v[92:95], v[72:75], v[64:67], v[92:95]
    ds_read_b64_tr_b16 v[54:55], v9 offset:10240
    v_mfma_f32_16x16x32_bf16 v[96:99], v[72:75], v[68:71], v[96:99]
    s_waitcnt lgkmcnt(6)
    v_mfma_f32_16x16x32_bf16 v[100:103], v[32:35], v[12:15], v[100:103]
    ds_read_b128 v[56:59], v6 offset:40960
    ds_read_b128 v[60:63], v6 offset:43008
    v_mfma_f32_16x16x32_bf16 v[84:87], v[32:35], v[16:19], v[84:87]
    ds_read_b128 v[64:67], v6 offset:45056
    ds_read_b128 v[68:71], v6 offset:47104
    v_mfma_f32_16x16x32_bf16 v[88:91], v[32:35], v[20:23], v[88:91]
    s_bitcmp1_b32 s38, 11
    s_cbranch_scc1 QS_OK11
QS_SP11:
    ds_read_b32 v136, v111
    s_waitcnt lgkmcnt(0)
    v_readfirstlane_b32 s38, v136
    s_bitcmp0_b32 s38, 11
    s_cbranch_scc1 QS_SP11
QS_OK11:
    ds_read_b64_tr_b16 v[72:73], v9 offset:12288
    v_mfma_f32_16x16x32_bf16 v[92:95], v[32:35], v[24:27], v[92:95]
    ds_read_b64_tr_b16 v[74:75], v9 offset:14336
    v_mfma_f32_16x16x32_bf16 v[96:99], v[32:35], v[28:31], v[96:99]
    s_waitcnt lgkmcnt(6)
    v_mfma_f32_16x16x32_bf16 v[100:103], v[52:55], v[12:15], v[100:103]
    ds_read_b128 v[16:19], v5 offset:49152
    ds_read_b128 v[20:23], v5 offset:51200
    v_mfma_f32_16x16x32_bf16 v[84:87], v[52:55], v[36:39], v[84:87]
    ds_read_b128 v[24:27], v5 offset:53248
    ds_read_b128 v[28:31], v5 offset:55296
    v_mfma_f32_16x16x32_bf16 v[88:91], v[52:55], v[40:43], v[88:91]
    s_bitcmp1_b32 s38, 12
    s_cbranch_scc1 QS_OK12
QS_SP12:
    ds_read_b32 v136, v111
    s_waitcnt lgkmcnt(0)
    v_readfirstlane_b32 s38, v136
    s_bitcmp0_b32 s38, 12
    s_cbranch_scc1 QS_SP12
QS_OK12:
    ds_read_b64_tr_b16 v[32:33], v9 offset:16384
    v_mfma_f32_16x16x32_bf16 v[92:95], v[52:55], v[44:47], v[92:95]
    ds_read_b64_tr_b16 v[34:35], v9 offset:18432
    v_mfma_f32_16x16x32_bf16 v[96:99], v[52:55], v[48:51], v[96:99]
    s_waitcnt lgkmcnt(6)
    v_mfma_f32_16x16x32_bf16 v[100:103], v[72:75], v[12:15], v[100:103]
    ds_read_b128 v[36:39], v6 offset:49152
    ds_read_b128 v[40:43], v6 offset:51200
    v_mfma_f32_16x16x32_bf16 v[84:87], v[72:75], v[56:59], v[84:87]
    ds_read_b128 v[44:47], v6 offset:53248
    ds_read_b128 v[48:51], v6 offset:55296
    v_mfma_f32_16x16x32_bf16 v[88:91], v[72:75], v[60:63], v[88:91]
    s_bitcmp1_b32 s38, 13
    s_cbranch_scc1 QS_OK13
QS_SP13:
    ds_read_b32 v136, v111
    s_waitcnt lgkmcnt(0)
    v_readfirstlane_b32 s38, v136
    s_bitcmp0_b32 s38, 13
    s_cbranch_scc1 QS_SP13
QS_OK13:
    ds_read_b64_tr_b16 v[52:53], v9 offset:20480
    v_mfma_f32_16x16x32_bf16 v[92:95], v[72:75], v[64:67], v[92:95]
    ds_read_b64_tr_b16 v[54:55], v9 offset:22528
    v_mfma_f32_16x16x32_bf16 v[96:99], v[72:75], v[68:71], v[96:99]
    s_waitcnt lgkmcnt(6)
    v_mfma_f32_16x16x32_bf16 v[100:103], v[32:35], v[12:15], v[100:103]
    ds_read_b128 v[56:59], v5 offset:57344
    ds_read_b128 v[60:63], v5 offset:59392
    v_mfma_f32_16x16x32_bf16 v[84:87], v[32:35], v[16:19], v[84:87]
    ds_read_b128 v[64:67], v5 offset:61440
    ds_read_b128 v[68:71], v5 offset:63488
    v_mfma_f32_16x16x32_bf16 v[88:91], v[32:35], v[20:23], v[88:91]
    s_bitcmp1_b32 s38, 14
    s_cbranch_scc1 QS_OK14
QS_SP14:
    ds_read_b32 v136, v111
    s_waitcnt lgkmcnt(0)
    v_readfirstlane_b32 s38, v136
    s_bitcmp0_b32 s38, 14
    s_cbranch_scc1 QS_SP14
QS_OK14:
    ds_read_b64_tr_b16 v[72:73], v9 offset:24576
    v_mfma_f32_16x16x32_bf16 v[92:95], v[32:35], v[24:27], v[92:95]
    ds_read_b64_tr_b16 v[74:75], v9 offset:26624
    v_mfma_f32_16x16x32_bf16 v[96:99], v[32:35], v[28:31], v[96:99]
    s_waitcnt lgkmcnt(6)
    v_mfma_f32_16x16x32_bf16 v[100:103], v[52:55], v[12:15], v[100:103]
    ds_read_b128 v[16:19], v6 offset:57344
    ds_read_b128 v[20:23], v6 offset:59392
    v_mfma_f32_16x16x32_bf16 v[84:87], v[52:55], v[36:39], v[84:87]
    ds_read_b128 v[24:27], v6 offset:61440
    ds_read_b128 v[28:31], v6 offset:63488
    v_mfma_f32_16x16x32_bf16 v[88:91], v[52:55], v[40:43], v[88:91]
    s_bitcmp1_b32 s38, 15
    s_cbranch_scc1 QS_OK15
QS_SP15:
    ds_read_b32 v136, v111
    s_waitcnt lgkmcnt(0)
    v_readfirstlane_b32 s38, v136
    s_bitcmp0_b32 s38, 15
    s_cbranch_scc1 QS_SP15
QS_OK15:
    ds_read_b64_tr_b16 v[32:33], v9 offset:28672
    v_mfma_f32_16x16x32_bf16 v[92:95], v[52:55], v[44:47], v[92:95]
    ds_read_b64_tr_b16 v[34:35], v9 offset:30720
    v_mfma_f32_16x16x32_bf16 v[96:99], v[52:55], v[48:51], v[96:99]
    s_waitcnt lgkmcnt(6)
    v_mfma_f32_16x16x32_bf16 v[100:103], v[72:75], v[12:15], v[100:103]
    v_mfma_f32_16x16x32_bf16 v[84:87], v[72:75], v[56:59], v[84:87]
    v_mfma_f32_16x16x32_bf16 v[88:91], v[72:75], v[60:63], v[88:91]
    v_mfma_f32_16x16x32_bf16 v[92:95], v[72:75], v[64:67], v[92:95]
    v_mfma_f32_16x16x32_bf16 v[96:99], v[72:75], v[68:71], v[96:99]
    s_waitcnt lgkmcnt(0)
    s_mov_b64 exec, 1
    v_mov_b32 v137, 1
    ds_add_u32 v111, v137 offset:68
    s_mov_b64 exec, -1
    ds_read_b64 v[138:139], v111 offset:8
    v_mfma_f32_16x16x32_bf16 v[100:103], v[32:35], v[12:15], v[100:103]
    v_mfma_f32_16x16x32_bf16 v[84:87], v[32:35], v[16:19], v[84:87]
    v_mfma_f32_16x16x32_bf16 v[88:91], v[32:35], v[20:23], v[88:91]
    v_mfma_f32_16x16x32_bf16 v[92:95], v[32:35], v[24:27], v[92:95]
    v_mfma_f32_16x16x32_bf16 v[96:99], v[32:35], v[28:31], v[96:99]
    s_waitcnt lgkmcnt(0)
    v_readfirstlane_b32 s14, v138
    v_readfirstlane_b32 s9, v139
    s_mul_i32 s9, s9, s14
    s_cmp_lg_u32 s9, 0
    s_nop 2
    s_cbranch_scc1 QS_ZWX
QS_ZW:
    ds_read_b64 v[138:139], v111 offset:8
    s_waitcnt lgkmcnt(0)
    v_readfirstlane_b32 s14, v138
    v_readfirstlane_b32 s9, v139
    s_mul_i32 s9, s9, s14
    s_cmp_eq_u32 s9, 0
    s_nop 2
    s_cbranch_scc1 QS_ZW
QS_ZWX:
    s_cmp_lg_u32 s14, 1
    s_cbranch_scc1 QS_SKIP
    v_pk_fma_f32 v[84:85], v[112:113], v[100:101], v[84:85] op_sel:[0,0,0] op_sel_hi:[0,1,1] neg_lo:[1,0,0] neg_hi:[1,0,0]
    v_pk_fma_f32 v[86:87], v[112:113], v[102:103], v[86:87] op_sel:[0,0,0] op_sel_hi:[0,1,1] neg_lo:[1,0,0] neg_hi:[1,0,0]
    v_pk_fma_f32 v[84:85], v[84:85], v[112:113], v[120:121] op_sel:[0,1,0] op_sel_hi:[1,1,1]
    v_pk_fma_f32 v[86:87], v[86:87], v[112:113], v[120:121] op_sel:[0,1,0] op_sel_hi:[1,1,1]
    v_pk_mul_f32 v[124:125], v[84:85], v[122:123]
    v_pk_mul_f32 v[126:127], v[86:87], v[122:123]
    v_min_f32 v124, 0, v124
    v_min_f32 v125, 0, v125
    v_min_f32 v126, 0, v126
    v_min_f32 v127, 0, v127
    v_exp_f32 v124, v124
    v_exp_f32 v125, v125
    v_exp_f32 v126, v126
    v_exp_f32 v127, v127
    v_max_f32 v84, s39, v84
    v_max_f32 v85, s39, v85
    v_max_f32 v86, s39, v86
    v_max_f32 v87, s39, v87
    v_pk_add_f32 v[84:85], v[84:85], v[124:125]
    v_pk_add_f32 v[86:87], v[86:87], v[126:127]
    v_cvt_pk_bf16_f32 v128, v84, v85
    v_cvt_pk_bf16_f32 v129, v86, v87
    v_pk_fma_f32 v[88:89], v[114:115], v[100:101], v[88:89] op_sel:[0,0,0] op_sel_hi:[0,1,1] neg_lo:[1,0,0] neg_hi:[1,0,0]
    v_pk_fma_f32 v[90:91], v[114:115], v[102:103], v[90:91] op_sel:[0,0,0] op_sel_hi:[0,1,1] neg_lo:[1,0,0] neg_hi:[1,0,0]
    v_pk_fma_f32 v[88:89], v[88:89], v[114:115], v[120:121] op_sel:[0,1,0] op_sel_hi:[1,1,1]
    v_pk_fma_f32 v[90:91], v[90:91], v[114:115], v[120:121] op_sel:[0,1,0] op_sel_hi:[1,1,1]
    v_pk_mul_f32 v[124:125], v[88:89], v[122:123]
    v_pk_mul_f32 v[126:127], v[90:91], v[122:123]
    v_min_f32 v124, 0, v124
    v_min_f32 v125, 0, v125
    v_min_f32 v126, 0, v126
    v_min_f32 v127, 0, v127
    v_exp_f32 v124, v124
    v_exp_f32 v125, v125
    v_exp_f32 v126, v126
    v_exp_f32 v127, v127
    v_max_f32 v88, s39, v88
    v_max_f32 v89, s39, v89
    v_max_f32 v90, s39, v90
    v_max_f32 v91, s39, v91
    v_pk_add_f32 v[88:89], v[88:89], v[124:125]
    v_pk_add_f32 v[90:91], v[90:91], v[126:127]
    v_cvt_pk_bf16_f32 v130, v88, v89
    v_cvt_pk_bf16_f32 v131, v90, v91
    buffer_store_dwordx4 v[128:131], v4, s[40:43], s13 offen sc1
    v_pk_fma_f32 v[92:93], v[116:117], v[100:101], v[92:93] op_sel:[0,0,0] op_sel_hi:[0,1,1] neg_lo:[1,0,0] neg_hi:[1,0,0]
    v_pk_fma_f32 v[94:95], v[116:117], v[102:103], v[94:95] op_sel:[0,0,0] op_sel_hi:[0,1,1] neg_lo:[1,0,0] neg_hi:[1,0,0]
    v_pk_fma_f32 v[92:93], v[92:93], v[116:117], v[120:121] op_sel:[0,1,0] op_sel_hi:[1,1,1]
    v_pk_fma_f32 v[94:95], v[94:95], v[116:117], v[120:121] op_sel:[0,1,0] op_sel_hi:[1,1,1]
    v_pk_mul_f32 v[124:125], v[92:93], v[122:123]
    v_pk_mul_f32 v[126:127], v[94:95], v[122:123]
    v_min_f32 v124, 0, v124
    v_min_f32 v125, 0, v125
    v_min_f32 v126, 0, v126
    v_min_f32 v127, 0, v127
    v_exp_f32 v124, v124
    v_exp_f32 v125, v125
    v_exp_f32 v126, v126
    v_exp_f32 v127, v127
    v_max_f32 v92, s39, v92
    v_max_f32 v93, s39, v93
    v_max_f32 v94, s39, v94
    v_max_f32 v95, s39, v95
    v_pk_add_f32 v[92:93], v[92:93], v[124:125]
    v_pk_add_f32 v[94:95], v[94:95], v[126:127]
    v_cvt_pk_bf16_f32 v132, v92, v93
    v_cvt_pk_bf16_f32 v133, v94, v95
    v_pk_fma_f32 v[96:97], v[118:119], v[100:101], v[96:97] op_sel:[0,0,0] op_sel_hi:[0,1,1] neg_lo:[1,0,0] neg_hi:[1,0,0]
    v_pk_fma_f32 v[98:99], v[118:119], v[102:103], v[98:99] op_sel:[0,0,0] op_sel_hi:[0,1,1] neg_lo:[1,0,0] neg_hi:[1,0,0]
    v_pk_fma_f32 v[96:97], v[96:97], v[118:119], v[120:121] op_sel:[0,1,0] op_sel_hi:[1,1,1]
    v_pk_fma_f32 v[98:99], v[98:99], v[118:119], v[120:121] op_sel:[0,1,0] op_sel_hi:[1,1,1]
    v_pk_mul_f32 v[124:125], v[96:97], v[122:123]
    v_pk_mul_f32 v[126:127], v[98:99], v[122:123]
    v_min_f32 v124, 0, v124
    v_min_f32 v125, 0, v125
    v_min_f32 v126, 0, v126
    v_min_f32 v127, 0, v127
    v_exp_f32 v124, v124
    v_exp_f32 v125, v125
    v_exp_f32 v126, v126
    v_exp_f32 v127, v127
    v_max_f32 v96, s39, v96
    v_max_f32 v97, s39, v97
    v_max_f32 v98, s39, v98
    v_max_f32 v99, s39, v99
    v_pk_add_f32 v[96:97], v[96:97], v[124:125]
    v_pk_add_f32 v[98:99], v[98:99], v[126:127]
    v_cvt_pk_bf16_f32 v134, v96, v97
    v_cvt_pk_bf16_f32 v135, v98, v99
    buffer_store_dwordx4 v[132:135], v4, s[40:43], s13 offen offset:1024 sc1
    s_nop 1
QS_SKIP:
    s_mov_b64 exec, 1
    v_mov_b32 v137, 256
    ds_add_u32 v111, v137 offset:68
    s_cmp_lg_u32 s14, 1
    s_nop 0
    s_cbranch_scc1 QS_NOFL
    s_waitcnt vmcnt(0)
    buffer_store_byte v146, v140, s[56:59], s12 offen sc1
QS_NOFL:
    v_mov_b32 v137, 65536
    ds_add_u32 v111, v137 offset:68
    s_mov_b64 exec, -1
    s_nop 0
QS_QW:
    ds_read2_b32 v[136:137], v111 offset0:17 offset1:18
    s_waitcnt lgkmcnt(0)
    v_readfirstlane_b32 s9, v137
    s_cmp_eq_u32 s9, 0
    s_nop 3
    s_cbranch_scc1 QS_QW
    s_bfe_u32 s6, s9, 0x80008
    s_bfe_u32 s7, s9, 0x80010
    s_bitcmp1_b32 s9, 0
    s_cbranch_scc1 QS_ENTRY
CA_INIT:
    s_getreg_b32 s4, hwreg(HW_REG_XCC_ID, 0, 3)
    s_lshr_b32 s5, s2, 3
    s_mov_b32 s10, 1
    s_mov_b32 s63, 0xffff0000
CA_ENTRY:
    s_and_b32 s11, s3, 3
    s_lshr_b32 s12, s3, 2
    s_lshl_b32 s9, s11, 2
    s_add_u32 s9, s9, 163792
    v_mov_b32 v14, s9
    v_mov_b32 v15, 1
    v_subrev_u32 v155, 48, v14
    v_mov_b32 v156, 1
    s_add_u32 s9, s9, 32
    s_cmp_eq_u32 s12, 0
    s_cselect_b32 s9, s9, 163788
    v_mov_b32 v150, s9
PGS2:
    s_cbranch_execz PGS3
    s_and_b32 s6, s5, 3
    s_lshl_b32 s9, s4, 2
    s_add_u32 s6, s6, s9
    s_lshr_b32 s7, s5, 2
    s_mov_b32 s44, s16
    s_and_b32 s45, s17, 0xffff
    s_mov_b32 s46, 2097152
    s_mov_b32 s47, 0x20000
    v_lshrrev_b32 v6, 2, v2
    v_lshl_add_u32 v8, v3, 2, v6
    v_bfe_u32 v7, v8, 1, 2
    v_lshlrev_b32 v8, 7, v8
    v_lshl_add_u32 v8, v7, 5, v8
    v_and_b32 v7, 3, v1
    v_lshl_add_u32 v8, v7, 3, v8
    s_lshl_b32 s9, s11, 14
    v_add_u32 v8, s9, v8
    v_xor_b32 v9, 32, v8
    v_xor_b32 v10, 64, v8
    v_xor_b32 v11, 96, v8
    s_lshr_b32 s38, s3, 1
    s_lshl_b32 s38, s38, 4
    s_lshl_b32 s13, s6, 6
    s_add_u32 s38, s38, s13
    v_add_u32 v12, s38, v2
    v_lshlrev_b32 v13, 10, v12
    v_lshl_add_u32 v13, v3, 3, v13
    s_and_b32 s13, s3, 1
    s_lshl_b32 s14, s7, 1
    s_add_u32 s13, s13, s14
    s_lshl_b32 s14, s13, 6
    buffer_load_dwordx2 v[80:81], v13, s[44:47], s14 offen
    buffer_load_dwordx2 v[82:83], v13, s[44:47], s14 offen offset:32
    s_add_u32 s44, s36, 14155776
    s_addc_u32 s45, s37, 0
    s_and_b32 s45, s45, 0xffff
    s_mov_b32 s46, 40960
    s_mov_b32 s47, 0x20000
    s_mov_b32 s40, s36
    s_and_b32 s41, s37, 0xffff
    s_mov_b32 s42, 2097152
    s_mov_b32 s43, 0x20000
    s_add_u32 s48, s36, 2097152
    s_addc_u32 s49, s37, 0
    s_and_b32 s49, s49, 0xffff
    s_mov_b32 s50, 2097152
    s_mov_b32 s51, 0x20000
    s_add_u32 s52, s36, 14680064
    s_addc_u32 s53, s37, 0
    s_and_b32 s53, s53, 0xffff
    s_mov_b32 s54, 262144
    s_mov_b32 s55, 0x20000
    s_add_u32 s56, s36, 15728640
    s_addc_u32 s57, s37, 0
    s_and_b32 s57, s57, 0xffff
    s_mov_b32 s58, 131072
    s_mov_b32 s59, 0x20000
    s_lshl_b32 s9, s11, 13
    s_add_u32 s9, s9, 65536
    v_lshl_add_u32 v148, v1, 2, s9
    s_lshl_b32 s9, s11, 9
    s_add_u32 s9, s9, 156672
    v_lshl_add_u32 v149, v3, 4, s9
    s_lshl_b32 s15, s6, 5
    s_lshl_b32 s9, s11, 3
    s_add_u32 s15, s15, s9
    s_lshl_b32 s15, s15, 1
    s_add_u32 s15, s15, s12
    s_lshl_b32 s15, s15, 10
    s_lshl_b32 s39, s11, 9
    v_and_b32 v16, 1, v1
    v_lshl_add_u32 v16, v16, 8, s39
    s_lshl_b32 s9, s6, 11
    s_add_u32 s39, s9, 65536
    s_getreg_b32 s64, hwreg(HW_REG_XCC_ID, 0, 3)
    s_lshl_b32 s64, s64, 11
    s_add_u32 s64, s64, 32768
    v_mov_b32 v21, 0x01010101
    s_mov_b64 exec, 3
    v_add_u32 v16, s64, v16
    s_mov_b64 exec, 12
    v_add_u32 v16, s39, v16
    s_mov_b64 exec, -1
    v_lshrrev_b32 v17, 2, v1
    v_and_b32 v18, 3, v1
    v_lshlrev_b32 v18, 4, v18
    v_lshl_add_u32 v17, v17, 8, v18
    v_mov_b32 v18, 3
    v_mov_b32 v19, 7
    s_mov_b32 s60, 0x01010101
    s_mov_b32 s61, 524288
    s_cmp_ge_u32 s3, 4
    s_cbranch_scc1 CA_PQ
    s_mov_b64 exec, 15
CA_P1:
    buffer_load_dword v20, v16, s[56:59], 0 offen sc1
    s_waitcnt vmcnt(0)
    v_cmp_ne_u32 vcc, v21, v20
    s_and_b32 s65, vcc_lo, 12
    s_and_b32 s9, vcc_lo, 3
    s_nop 2
    s_cbranch_scc0 CA_K1
    s_cmp_eq_u32 s65, 0
    s_cbranch_scc1 CA_Q1
    s_sub_u32 s61, s61, 1
    s_cmp_gt_i32 s61, 0
    s_cbranch_scc1 CA_P1
CA_Q1:
    s_mov_b64 exec, -1
    ds_write_b32 v14, v15
    s_add_u32 s9, s15, 0
    buffer_load_dwordx4 v[48:51], v4, s[40:43], s9 offen
    buffer_load_dwordx4 v[52:55], v4, s[40:43], s9 offen offset:2048
    s_add_u32 s9, s15, 4096
    buffer_load_dwordx4 v[56:59], v4, s[40:43], s9 offen
    buffer_load_dwordx4 v[60:63], v4, s[40:43], s9 offen offset:2048
    s_add_u32 s9, s15, 8192
    buffer_load_dwordx4 v[64:67], v4, s[40:43], s9 offen
    buffer_load_dwordx4 v[68:71], v4, s[40:43], s9 offen offset:2048
    s_add_u32 s9, s15, 12288
    buffer_load_dwordx4 v[72:75], v4, s[40:43], s9 offen
    buffer_load_dwordx4 v[76:79], v4, s[40:43], s9 offen offset:2048
    s_mov_b64 exec, 3
CA_P2:
    buffer_load_dword v20, v16, s[56:59], 0 offen sc1
    s_waitcnt vmcnt(0)
    v_cmp_ne_u32 vcc, v21, v20
    s_nop 4
    s_cbranch_vccz CA_K2
    s_sub_u32 s61, s61, 1
    s_cmp_gt_i32 s61, 0
    s_cbranch_scc1 CA_P2
CA_K2:
    s_mov_b64 exec, -1
    s_lshl_b32 s62, s3, 9
    s_lshl_b32 s9, s3, 11
    s_add_u32 s9, s9, 32768
    s_add_u32 m0, s62, 156672
    s_mov_b32 exec_hi, 0
    buffer_load_dwordx4 v17, s[44:47], s9 offen lds
    s_mov_b32 exec_hi, -1
    s_lshl_b32 s62, s3, 13
    s_add_u32 s9, s62, 0
    s_add_u32 m0, s62, 65536
    s_nop 0
    buffer_load_dwordx4 v4, s[44:47], s9 offen lds
    s_add_u32 s9, s62, 1024
    s_add_u32 m0, s62, 66560
    s_nop 0
    buffer_load_dwordx4 v4, s[44:47], s9 offen lds
    s_add_u32 s9, s62, 2048
    s_add_u32 m0, s62, 67584
    s_nop 0
    buffer_load_dwordx4 v4, s[44:47], s9 offen lds
    s_add_u32 s9, s62, 3072
    s_add_u32 m0, s62, 68608
    s_nop 0
    buffer_load_dwordx4 v4, s[44:47], s9 offen lds
    s_add_u32 s9, s62, 4096
    s_add_u32 m0, s62, 69632
    s_nop 0
    buffer_load_dwordx4 v4, s[44:47], s9 offen lds
    s_add_u32 s9, s62, 5120
    s_add_u32 m0, s62, 70656
    s_nop 0
    buffer_load_dwordx4 v4, s[44:47], s9 offen lds
    s_add_u32 s9, s62, 6144
    s_add_u32 m0, s62, 71680
    s_nop 0
    buffer_load_dwordx4 v4, s[44:47], s9 offen lds
    s_add_u32 s9, s62, 7168
    s_add_u32 m0, s62, 72704
    s_nop 0
    buffer_load_dwordx4 v4, s[44:47], s9 offen lds
    ds_write_b32 v14, v18
    s_waitcnt vmcnt(0)
    s_branch CA_NB0
CA_PQ:
    ds_read_b32 v15, v14
    s_waitcnt lgkmcnt(0)
    v_readfirstlane_b32 s9, v15
    s_cmp_eq_u32 s9, 0
    s_nop 3
    s_cbranch_scc1 CA_PQ
    s_branch CA_Q3
CA_K1:
    s_mov_b64 exec, -1
    s_lshl_b32 s62, s3, 9
    s_lshl_b32 s9, s3, 11
    s_add_u32 s9, s9, 32768
    s_add_u32 m0, s62, 156672
    s_mov_b32 exec_hi, 0
    buffer_load_dwordx4 v17, s[44:47], s9 offen lds
    s_mov_b32 exec_hi, -1
    s_lshl_b32 s62, s3, 13
    s_add_u32 s9, s62, 0
    s_add_u32 m0, s62, 65536
    s_nop 0
    buffer_load_dwordx4 v4, s[44:47], s9 offen lds
    s_add_u32 s9, s62, 1024
    s_add_u32 m0, s62, 66560
    s_nop 0
    buffer_load_dwordx4 v4, s[44:47], s9 offen lds
    s_add_u32 s9, s62, 2048
    s_add_u32 m0, s62, 67584
    s_nop 0
    buffer_load_dwordx4 v4, s[44:47], s9 offen lds
    s_add_u32 s9, s62, 3072
    s_add_u32 m0, s62, 68608
    s_nop 0
    buffer_load_dwordx4 v4, s[44:47], s9 offen lds
    s_add_u32 s9, s62, 4096
    s_add_u32 m0, s62, 69632
    s_nop 0
    buffer_load_dwordx4 v4, s[44:47], s9 offen lds
    s_add_u32 s9, s62, 5120
    s_add_u32 m0, s62, 70656
    s_nop 0
    buffer_load_dwordx4 v4, s[44:47], s9 offen lds
    s_add_u32 s9, s62, 6144
    s_add_u32 m0, s62, 71680
    s_nop 0
    buffer_load_dwordx4 v4, s[44:47], s9 offen lds
    s_add_u32 s9, s62, 7168
    s_add_u32 m0, s62, 72704
    s_nop 0
    buffer_load_dwordx4 v4, s[44:47], s9 offen lds
    s_cmp_eq_u32 s65, 0
    s_cbranch_scc1 CA_Q2
    s_mov_b64 exec, 12
CA_P3:
    buffer_load_dword v20, v16, s[56:59], 0 offen sc1
    s_waitcnt vmcnt(0)
    v_cmp_ne_u32 vcc, v21, v20
    s_nop 4
    s_cbranch_vccz CA_Q2
    s_sub_u32 s61, s61, 1
    s_cmp_gt_i32 s61, 0
    s_cbranch_scc1 CA_P3
CA_Q2:
    s_mov_b64 exec, -1
    ds_write_b32 v14, v18
CA_Q3:
    s_add_u32 s9, s15, 0
    buffer_load_dwordx4 v[48:51], v4, s[40:43], s9 offen
    buffer_load_dwordx4 v[52:55], v4, s[40:43], s9 offen offset:2048
    s_add_u32 s9, s15, 4096
    buffer_load_dwordx4 v[56:59], v4, s[40:43], s9 offen
    buffer_load_dwordx4 v[60:63], v4, s[40:43], s9 offen offset:2048
    s_add_u32 s9, s15, 8192
    buffer_load_dwordx4 v[64:67], v4, s[40:43], s9 offen
    buffer_load_dwordx4 v[68:71], v4, s[40:43], s9 offen offset:2048
    s_add_u32 s9, s15, 12288
    buffer_load_dwordx4 v[72:75], v4, s[40:43], s9 offen
    buffer_load_dwordx4 v[76:79], v4, s[40:43], s9 offen offset:2048
    s_waitcnt vmcnt(8)
    s_cmp_lt_u32 s3, 4
    s_cbranch_scc1 CA_NB0
CA_SPIN:
    ds_read_b32 v15, v14
    s_waitcnt lgkmcnt(0)
    v_readfirstlane_b32 s9, v15
    s_cmp_lg_u32 s9, 7
    s_nop 3
    s_cbranch_scc1 CA_SPIN
CA_NB0:
    ds_write_b32 v14, v19
    ds_read2st64_b32 v[84:85], v148 offset0:0 offset1:1
    ds_read2st64_b32 v[86:87], v148 offset0:2 offset1:3
    ds_read_b128 v[88:91], v149
    ds_read2st64_b32 v[92:93], v148 offset0:4 offset1:5
    ds_read2st64_b32 v[94:95], v148 offset0:6 offset1:7
    ds_read_b128 v[96:99], v149 offset:64
    ds_read2st64_b32 v[100:101], v148 offset0:8 offset1:9
    ds_read2st64_b32 v[102:103], v148 offset0:10 offset1:11
    ds_read_b128 v[104:107], v149 offset:128
    ds_read2st64_b32 v[108:109], v148 offset0:12 offset1:13
    ds_read2st64_b32 v[110:111], v148 offset0:14 offset1:15
    ds_read_b128 v[112:115], v149 offset:192
    ds_read2st64_b32 v[116:117], v148 offset0:16 offset1:17
    ds_read2st64_b32 v[118:119], v148 offset0:18 offset1:19
    ds_read_b128 v[120:123], v149 offset:256
    ds_read2st64_b32 v[124:125], v148 offset0:20 offset1:21
    ds_read2st64_b32 v[126:127], v148 offset0:22 offset1:23
    ds_read_b128 v[128:131], v149 offset:320
    ds_read2st64_b32 v[132:133], v148 offset0:24 offset1:25
    ds_read2st64_b32 v[134:135], v148 offset0:26 offset1:27
    ds_read_b128 v[136:139], v149 offset:384
    ds_read2st64_b32 v[140:141], v148 offset0:28 offset1:29
    ds_read2st64_b32 v[142:143], v148 offset0:30 offset1:31
    ds_read_b128 v[144:147], v149 offset:448
    s_waitcnt lgkmcnt(12)
    v_cvt_pk_bf16_f32 v16, v84, v85
    v_cvt_pk_bf16_f32 v17, v86, v87
    v_cvt_pk_bf16_f32 v18, v88, v89
    v_cvt_pk_bf16_f32 v19, v90, v91
    v_cvt_pk_bf16_f32 v20, v92, v93
    v_cvt_pk_bf16_f32 v21, v94, v95
    v_cvt_pk_bf16_f32 v22, v96, v97
    v_cvt_pk_bf16_f32 v23, v98, v99
    v_cvt_pk_bf16_f32 v24, v100, v101
    v_cvt_pk_bf16_f32 v25, v102, v103
    v_cvt_pk_bf16_f32 v26, v104, v105
    v_cvt_pk_bf16_f32 v27, v106, v107
    v_cvt_pk_bf16_f32 v28, v108, v109
    v_cvt_pk_bf16_f32 v29, v110, v111
    v_cvt_pk_bf16_f32 v30, v112, v113
    v_cvt_pk_bf16_f32 v31, v114, v115
    s_waitcnt lgkmcnt(0)
    ds_write_b32 v150, v15
    v_cvt_pk_bf16_f32 v32, v116, v117
    v_cvt_pk_bf16_f32 v33, v118, v119
    v_cvt_pk_bf16_f32 v34, v120, v121
    v_cvt_pk_bf16_f32 v35, v122, v123
    v_cvt_pk_bf16_f32 v36, v124, v125
    v_cvt_pk_bf16_f32 v37, v126, v127
    v_cvt_pk_bf16_f32 v38, v128, v129
    v_cvt_pk_bf16_f32 v39, v130, v131
    v_cvt_pk_bf16_f32 v40, v132, v133
    v_cvt_pk_bf16_f32 v41, v134, v135
    v_cvt_pk_bf16_f32 v42, v136, v137
    v_cvt_pk_bf16_f32 v43, v138, v139
    v_cvt_pk_bf16_f32 v44, v140, v141
    v_cvt_pk_bf16_f32 v45, v142, v143
    v_cvt_pk_bf16_f32 v46, v144, v145
    v_cvt_pk_bf16_f32 v47, v146, v147
    s_mov_b32 s39, 0x358637bd
    s_waitcnt vmcnt(6)
    v_mfma_f32_16x16x16_bf16 v[120:123], v[18:19], v[48:49], 0
    v_mfma_f32_16x16x16_bf16 v[116:119], v[16:17], v[48:49], 0
    v_mfma_f32_16x16x16_bf16 v[128:131], v[22:23], v[52:53], 0
    v_mfma_f32_16x16x16_bf16 v[124:127], v[20:21], v[52:53], 0
    v_mfma_f32_16x16x16_bf16 v[136:139], v[18:19], v[50:51], 0
    v_mfma_f32_16x16x16_bf16 v[132:135], v[16:17], v[50:51], 0
    v_mfma_f32_16x16x16_bf16 v[144:147], v[22:23], v[54:55], 0
    v_mfma_f32_16x16x16_bf16 v[140:143], v[20:21], v[54:55], 0
    s_nop 0
    v_add_f32 v120, s39, v120
    v_rcp_f32 v120, v120
    v_add_f32 v128, s39, v128
    v_rcp_f32 v128, v128
    v_mul_f32 v116, v116, v120
    v_mul_f32 v117, v117, v120
    v_mul_f32 v118, v118, v120
    v_mul_f32 v119, v119, v120
    v_cvt_pk_bf16_f32 v48, v116, v117
    v_cvt_pk_bf16_f32 v49, v118, v119
    v_mul_f32 v124, v124, v128
    v_mul_f32 v125, v125, v128
    v_mul_f32 v126, v126, v128
    v_mul_f32 v127, v127, v128
    v_cvt_pk_bf16_f32 v50, v124, v125
    v_cvt_pk_bf16_f32 v51, v126, v127
    s_waitcnt vmcnt(4)
    v_mfma_f32_16x16x16_bf16 v[120:123], v[26:27], v[56:57], 0
    v_mfma_f32_16x16x16_bf16 v[116:119], v[24:25], v[56:57], 0
    v_mfma_f32_16x16x16_bf16 v[128:131], v[30:31], v[60:61], 0
    v_mfma_f32_16x16x16_bf16 v[124:127], v[28:29], v[60:61], 0
    v_add_f32 v136, s39, v136
    v_rcp_f32 v136, v136
    v_add_f32 v144, s39, v144
    v_rcp_f32 v144, v144
    v_mul_f32 v132, v132, v136
    v_mul_f32 v133, v133, v136
    v_mul_f32 v134, v134, v136
    v_mul_f32 v135, v135, v136
    v_cvt_pk_bf16_f32 v52, v132, v133
    v_cvt_pk_bf16_f32 v53, v134, v135
    v_mul_f32 v140, v140, v144
    v_mul_f32 v141, v141, v144
    v_mul_f32 v142, v142, v144
    v_mul_f32 v143, v143, v144
    v_cvt_pk_bf16_f32 v54, v140, v141
    v_cvt_pk_bf16_f32 v55, v142, v143
    v_mfma_f32_16x16x16_bf16 v[136:139], v[26:27], v[58:59], 0
    v_mfma_f32_16x16x16_bf16 v[132:135], v[24:25], v[58:59], 0
    v_mfma_f32_16x16x16_bf16 v[144:147], v[30:31], v[62:63], 0
    v_mfma_f32_16x16x16_bf16 v[140:143], v[28:29], v[62:63], 0
    v_add_f32 v120, s39, v120
    v_rcp_f32 v120, v120
    v_add_f32 v128, s39, v128
    v_rcp_f32 v128, v128
    v_mul_f32 v116, v116, v120
    v_mul_f32 v117, v117, v120
    v_mul_f32 v118, v118, v120
    v_mul_f32 v119, v119, v120
    v_cvt_pk_bf16_f32 v56, v116, v117
    v_cvt_pk_bf16_f32 v57, v118, v119
    v_mul_f32 v124, v124, v128
    v_mul_f32 v125, v125, v128
    v_mul_f32 v126, v126, v128
    v_mul_f32 v127, v127, v128
    v_cvt_pk_bf16_f32 v58, v124, v125
    v_cvt_pk_bf16_f32 v59, v126, v127
    s_waitcnt vmcnt(2)
    v_mfma_f32_16x16x16_bf16 v[120:123], v[34:35], v[64:65], 0
    v_mfma_f32_16x16x16_bf16 v[116:119], v[32:33], v[64:65], 0
    v_mfma_f32_16x16x16_bf16 v[128:131], v[38:39], v[68:69], 0
    v_mfma_f32_16x16x16_bf16 v[124:127], v[36:37], v[68:69], 0
    v_add_f32 v136, s39, v136
    v_rcp_f32 v136, v136
    v_add_f32 v144, s39, v144
    v_rcp_f32 v144, v144
    v_mul_f32 v132, v132, v136
    v_mul_f32 v133, v133, v136
    v_mul_f32 v134, v134, v136
    v_mul_f32 v135, v135, v136
    v_cvt_pk_bf16_f32 v60, v132, v133
    v_cvt_pk_bf16_f32 v61, v134, v135
    v_mul_f32 v140, v140, v144
    v_mul_f32 v141, v141, v144
    v_mul_f32 v142, v142, v144
    v_mul_f32 v143, v143, v144
    v_cvt_pk_bf16_f32 v62, v140, v141
    v_cvt_pk_bf16_f32 v63, v142, v143
    v_mfma_f32_16x16x16_bf16 v[136:139], v[34:35], v[66:67], 0
    v_mfma_f32_16x16x16_bf16 v[132:135], v[32:33], v[66:67], 0
    v_mfma_f32_16x16x16_bf16 v[144:147], v[38:39], v[70:71], 0
    v_mfma_f32_16x16x16_bf16 v[140:143], v[36:37], v[70:71], 0
    v_add_f32 v120, s39, v120
    v_rcp_f32 v120, v120
    v_add_f32 v128, s39, v128
    v_rcp_f32 v128, v128
    v_mul_f32 v116, v116, v120
    v_mul_f32 v117, v117, v120
    v_mul_f32 v118, v118, v120
    v_mul_f32 v119, v119, v120
    v_cvt_pk_bf16_f32 v64, v116, v117
    v_cvt_pk_bf16_f32 v65, v118, v119
    v_mul_f32 v124, v124, v128
    v_mul_f32 v125, v125, v128
    v_mul_f32 v126, v126, v128
    v_mul_f32 v127, v127, v128
    v_cvt_pk_bf16_f32 v66, v124, v125
    v_cvt_pk_bf16_f32 v67, v126, v127
    s_waitcnt vmcnt(0)
    v_mfma_f32_16x16x16_bf16 v[120:123], v[42:43], v[72:73], 0
    v_mfma_f32_16x16x16_bf16 v[116:119], v[40:41], v[72:73], 0
    v_mfma_f32_16x16x16_bf16 v[128:131], v[46:47], v[76:77], 0
    v_mfma_f32_16x16x16_bf16 v[124:127], v[44:45], v[76:77], 0
    v_add_f32 v136, s39, v136
    v_rcp_f32 v136, v136
    v_add_f32 v144, s39, v144
    v_rcp_f32 v144, v144
    v_mul_f32 v132, v132, v136
    v_mul_f32 v133, v133, v136
    v_mul_f32 v134, v134, v136
    v_mul_f32 v135, v135, v136
    v_cvt_pk_bf16_f32 v68, v132, v133
    v_cvt_pk_bf16_f32 v69, v134, v135
    v_mul_f32 v140, v140, v144
    v_mul_f32 v141, v141, v144
    v_mul_f32 v142, v142, v144
    v_mul_f32 v143, v143, v144
    v_cvt_pk_bf16_f32 v70, v140, v141
    v_cvt_pk_bf16_f32 v71, v142, v143
    v_mfma_f32_16x16x16_bf16 v[136:139], v[42:43], v[74:75], 0
    v_mfma_f32_16x16x16_bf16 v[132:135], v[40:41], v[74:75], 0
    v_mfma_f32_16x16x16_bf16 v[144:147], v[46:47], v[78:79], 0
    v_mfma_f32_16x16x16_bf16 v[140:143], v[44:45], v[78:79], 0
    v_add_f32 v120, s39, v120
    v_rcp_f32 v120, v120
    v_add_f32 v128, s39, v128
    v_rcp_f32 v128, v128
    v_mul_f32 v116, v116, v120
    v_mul_f32 v117, v117, v120
    v_mul_f32 v118, v118, v120
    v_mul_f32 v119, v119, v120
    v_cvt_pk_bf16_f32 v72, v116, v117
    v_cvt_pk_bf16_f32 v73, v118, v119
    v_mul_f32 v124, v124, v128
    v_mul_f32 v125, v125, v128
    v_mul_f32 v126, v126, v128
    v_mul_f32 v127, v127, v128
    v_cvt_pk_bf16_f32 v74, v124, v125
    v_cvt_pk_bf16_f32 v75, v126, v127
    v_add_f32 v136, s39, v136
    v_rcp_f32 v136, v136
    v_add_f32 v144, s39, v144
    v_rcp_f32 v144, v144
    v_mul_f32 v132, v132, v136
    v_mul_f32 v133, v133, v136
    v_mul_f32 v134, v134, v136
    v_mul_f32 v135, v135, v136
    v_cvt_pk_bf16_f32 v76, v132, v133
    v_cvt_pk_bf16_f32 v77, v134, v135
    v_mul_f32 v140, v140, v144
    v_mul_f32 v141, v141, v144
    v_mul_f32 v142, v142, v144
    v_mul_f32 v143, v143, v144
    v_cvt_pk_bf16_f32 v78, v140, v141
    v_cvt_pk_bf16_f32 v79, v142, v143
    s_mov_b32 s39, 0
    s_cmp_gt_u32 s39, 0
    s_nop 0
    s_cbranch_scc1 CA_WOK0
CA_WSP0:
    ds_read_b32 v15, v14 offset:16
    s_waitcnt lgkmcnt(0)
    v_readfirstlane_b32 s39, v15
    s_cmp_le_u32 s39, 0
    s_nop 3
    s_cbranch_scc1 CA_WSP0
CA_WOK0:
    ds_read_b64_tr_b16 v[84:85], v8
    ds_read_b64_tr_b16 v[86:87], v8 offset:2048
    ds_read_b64_tr_b16 v[88:89], v9
    ds_read_b64_tr_b16 v[90:91], v9 offset:2048
    ds_read_b64_tr_b16 v[92:93], v10
    ds_read_b64_tr_b16 v[94:95], v10 offset:2048
    ds_read_b64_tr_b16 v[96:97], v11
    ds_read_b64_tr_b16 v[98:99], v11 offset:2048
    s_cmp_gt_u32 s39, 1
    s_cbranch_scc1 CA_WOK1
CA_WSP1:
    ds_read_b32 v15, v14 offset:16
    s_waitcnt lgkmcnt(0)
    v_readfirstlane_b32 s39, v15
    s_cmp_le_u32 s39, 1
    s_nop 3
    s_cbranch_scc1 CA_WSP1
CA_WOK1:
    ds_read_b64_tr_b16 v[100:101], v8 offset:4096
    ds_read_b64_tr_b16 v[102:103], v8 offset:6144
    ds_read_b64_tr_b16 v[104:105], v9 offset:4096
    ds_read_b64_tr_b16 v[106:107], v9 offset:6144
    ds_read_b64_tr_b16 v[108:109], v10 offset:4096
    ds_read_b64_tr_b16 v[110:111], v10 offset:6144
    ds_read_b64_tr_b16 v[112:113], v11 offset:4096
    ds_read_b64_tr_b16 v[114:115], v11 offset:6144
    s_waitcnt lgkmcnt(8)
    v_mfma_f32_16x16x32_bf16 v[116:119], v[84:87], v[48:51], 0
    v_mfma_f32_16x16x32_bf16 v[132:135], v[84:87], v[52:55], 0
    v_mfma_f32_16x16x32_bf16 v[120:123], v[88:91], v[48:51], 0
    v_mfma_f32_16x16x32_bf16 v[136:139], v[88:91], v[52:55], 0
    v_mfma_f32_16x16x32_bf16 v[124:127], v[92:95], v[48:51], 0
    v_mfma_f32_16x16x32_bf16 v[140:143], v[92:95], v[52:55], 0
    v_mfma_f32_16x16x32_bf16 v[128:131], v[96:99], v[48:51], 0
    v_mfma_f32_16x16x32_bf16 v[144:147], v[96:99], v[52:55], 0
    s_cmp_gt_u32 s39, 2
    s_nop 6
    s_cbranch_scc1 CA_WOK2
CA_WSP2:
    ds_read_b32 v15, v14 offset:16
    s_waitcnt lgkmcnt(0)
    v_readfirstlane_b32 s39, v15
    s_cmp_le_u32 s39, 2
    s_nop 3
    s_cbranch_scc1 CA_WSP2
CA_WOK2:
    ds_read_b64_tr_b16 v[84:85], v8 offset:8192
    ds_read_b64_tr_b16 v[86:87], v8 offset:10240
    ds_read_b64_tr_b16 v[88:89], v9 offset:8192
    ds_read_b64_tr_b16 v[90:91], v9 offset:10240
    ds_read_b64_tr_b16 v[92:93], v10 offset:8192
    ds_read_b64_tr_b16 v[94:95], v10 offset:10240
    ds_read_b64_tr_b16 v[96:97], v11 offset:8192
    ds_read_b64_tr_b16 v[98:99], v11 offset:10240
    s_waitcnt lgkmcnt(8)
    v_mfma_f32_16x16x32_bf16 v[116:119], v[100:103], v[56:59], v[116:119]
    v_mfma_f32_16x16x32_bf16 v[132:135], v[100:103], v[60:63], v[132:135]
    v_mfma_f32_16x16x32_bf16 v[120:123], v[104:107], v[56:59], v[120:123]
    v_mfma_f32_16x16x32_bf16 v[136:139], v[104:107], v[60:63], v[136:139]
    v_mfma_f32_16x16x32_bf16 v[124:127], v[108:111], v[56:59], v[124:127]
    v_mfma_f32_16x16x32_bf16 v[140:143], v[108:111], v[60:63], v[140:143]
    v_mfma_f32_16x16x32_bf16 v[128:131], v[112:115], v[56:59], v[128:131]
    v_mfma_f32_16x16x32_bf16 v[144:147], v[112:115], v[60:63], v[144:147]
    s_cmp_gt_u32 s39, 3
    s_nop 6
    s_cbranch_scc1 CA_WOK3
CA_WSP3:
    ds_read_b32 v15, v14 offset:16
    s_waitcnt lgkmcnt(0)
    v_readfirstlane_b32 s39, v15
    s_cmp_le_u32 s39, 3
    s_nop 3
    s_cbranch_scc1 CA_WSP3
CA_WOK3:
    ds_read_b64_tr_b16 v[100:101], v8 offset:12288
    ds_read_b64_tr_b16 v[102:103], v8 offset:14336
    ds_read_b64_tr_b16 v[104:105], v9 offset:12288
    ds_read_b64_tr_b16 v[106:107], v9 offset:14336
    ds_read_b64_tr_b16 v[108:109], v10 offset:12288
    ds_read_b64_tr_b16 v[110:111], v10 offset:14336
    ds_read_b64_tr_b16 v[112:113], v11 offset:12288
    ds_read_b64_tr_b16 v[114:115], v11 offset:14336
    s_waitcnt lgkmcnt(8)
    v_mfma_f32_16x16x32_bf16 v[116:119], v[84:87], v[64:67], v[116:119]
    v_mfma_f32_16x16x32_bf16 v[132:135], v[84:87], v[68:71], v[132:135]
    v_mfma_f32_16x16x32_bf16 v[120:123], v[88:91], v[64:67], v[120:123]
    v_mfma_f32_16x16x32_bf16 v[136:139], v[88:91], v[68:71], v[136:139]
    v_mfma_f32_16x16x32_bf16 v[124:127], v[92:95], v[64:67], v[124:127]
    v_mfma_f32_16x16x32_bf16 v[140:143], v[92:95], v[68:71], v[140:143]
    v_mfma_f32_16x16x32_bf16 v[128:131], v[96:99], v[64:67], v[128:131]
    v_mfma_f32_16x16x32_bf16 v[144:147], v[96:99], v[68:71], v[144:147]
    s_waitcnt lgkmcnt(0)
    s_mov_b64 exec, 1
    ds_add_u32 v155, v156
    s_mov_b64 exec, -1
    v_mfma_f32_16x16x32_bf16 v[116:119], v[100:103], v[72:75], v[116:119]
    v_mfma_f32_16x16x32_bf16 v[132:135], v[100:103], v[76:79], v[132:135]
    v_mfma_f32_16x16x32_bf16 v[120:123], v[104:107], v[72:75], v[120:123]
    v_mfma_f32_16x16x32_bf16 v[136:139], v[104:107], v[76:79], v[136:139]
    v_mfma_f32_16x16x32_bf16 v[124:127], v[108:111], v[72:75], v[124:127]
    v_mfma_f32_16x16x32_bf16 v[140:143], v[108:111], v[76:79], v[140:143]
    v_mfma_f32_16x16x32_bf16 v[128:131], v[112:115], v[72:75], v[128:131]
    v_mfma_f32_16x16x32_bf16 v[144:147], v[112:115], v[76:79], v[144:147]
    s_nop 7
CA_RSP:
    ds_read_b32 v15, v14 offset:32
    s_waitcnt lgkmcnt(0)
    v_readfirstlane_b32 s9, v15
    s_cmp_eq_u32 s9, 0
    s_nop 3
    s_cbranch_scc1 CA_RSP
    s_lshl_b32 s15, s12, 15
    s_sub_u32 s15, 98304, s15
    s_lshl_b32 s9, s11, 13
    s_add_u32 s9, s9, s15
    v_add_u32 v148, s9, v4
    ds_write_b128 v148, v[116:119]
    ds_write_b128 v148, v[120:123] offset:1024
    ds_write_b128 v148, v[124:127] offset:2048
    ds_write_b128 v148, v[128:131] offset:3072
    ds_write_b128 v148, v[132:135] offset:4096
    ds_write_b128 v148, v[136:139] offset:5120
    ds_write_b128 v148, v[140:143] offset:6144
    ds_write_b128 v148, v[144:147] offset:7168
    s_lshl_b32 s9, s11, 11
    s_add_u32 s9, s9, s15
    v_add_u32 v148, s9, v4
    v_mov_b32 v152, 163776
    s_lshl_b32 s15, s4, 12
    s_and_b32 s9, s5, 3
    s_lshl_b32 s9, s9, 8
    s_add_u32 s15, s15, s9
    s_lshl_b32 s9, s7, 5
    s_add_u32 s15, s15, s9
    s_lshl_b32 s9, s3, 2
    s_add_u32 s15, s15, s9
    v_lshlrev_b32 v48, 16, v80
    v_and_b32 v49, s63, v80
    v_lshlrev_b32 v50, 16, v81
    v_and_b32 v51, s63, v81
    v_lshlrev_b32 v52, 16, v82
    v_and_b32 v53, s63, v82
    v_lshlrev_b32 v54, 16, v83
    v_and_b32 v55, s63, v83
    v_lshlrev_b32 v151, 7, v12
    v_mov_b32 v153, 1
    v_mov_b32 v154, 0
    v_mov_b32 v160, -1
    v_mov_b32 v161, -1
    s_lshl_b32 s39, s13, 3
    s_add_u32 s9, s38, s13
    s_lshl_b32 s9, s9, 10
    s_waitcnt lgkmcnt(0)
    s_barrier
    ds_read_b32 v152, v152
    ds_read_b128 v[16:19], v148
    ds_read_b128 v[20:23], v148 offset:1024
    ds_read_b128 v[24:27], v148 offset:8192
    ds_read_b128 v[28:31], v148 offset:9216
    ds_read_b128 v[32:35], v148 offset:16384
    ds_read_b128 v[36:39], v148 offset:17408
    ds_read_b128 v[40:43], v148 offset:24576
    ds_read_b128 v[44:47], v148 offset:25600
    s_waitcnt lgkmcnt(4)
    v_readfirstlane_b32 s11, v152
    v_pk_add_f32 v[16:17], v[16:17], v[24:25]
    v_pk_add_f32 v[18:19], v[18:19], v[26:27]
    v_pk_add_f32 v[20:21], v[20:21], v[28:29]
    v_pk_add_f32 v[22:23], v[22:23], v[30:31]
    s_cmp_eq_u32 s11, 0
    s_nop 1
    s_cbranch_scc1 CA_SKIP
    s_waitcnt lgkmcnt(0)
    v_pk_add_f32 v[32:33], v[32:33], v[40:41]
    v_pk_add_f32 v[34:35], v[34:35], v[42:43]
    v_pk_add_f32 v[36:37], v[36:37], v[44:45]
    v_pk_add_f32 v[38:39], v[38:39], v[46:47]
    v_pk_add_f32 v[16:17], v[16:17], v[32:33]
    v_pk_add_f32 v[18:19], v[18:19], v[34:35]
    v_pk_add_f32 v[20:21], v[20:21], v[36:37]
    v_pk_add_f32 v[22:23], v[22:23], v[38:39]
    v_cvt_pk_bf16_f32 v158, v16, v17
    v_lshlrev_b32 v16, 16, v158
    v_and_b32 v17, s63, v158
    v_cvt_pk_bf16_f32 v159, v18, v19
    v_lshlrev_b32 v18, 16, v159
    v_and_b32 v19, s63, v159
    v_cvt_pk_bf16_f32 v158, v20, v21
    v_lshlrev_b32 v20, 16, v158
PGS3:
    s_cbranch_execz PGS4
    v_and_b32 v21, s63, v158
    v_cvt_pk_bf16_f32 v159, v22, v23
    v_lshlrev_b32 v22, 16, v159
    v_and_b32 v23, s63, v159
    v_pk_add_f32 v[16:17], v[16:17], v[48:49]
    v_pk_add_f32 v[18:19], v[18:19], v[50:51]
    v_pk_add_f32 v[20:21], v[20:21], v[52:53]
    v_pk_add_f32 v[22:23], v[22:23], v[54:55]
    v_cvt_pk_bf16_f32 v32, v16, v17
    v_cvt_pk_bf16_f32 v33, v18, v19
    v_cvt_pk_bf16_f32 v34, v20, v21
    v_cvt_pk_bf16_f32 v35, v22, v23
    buffer_store_dwordx4 v[32:35], v4, s[48:51], s9 offen
    v_lshlrev_b32 v16, 16, v32
    v_and_b32 v17, s63, v32
    v_lshlrev_b32 v18, 16, v33
    v_and_b32 v19, s63, v33
    v_lshlrev_b32 v20, 16, v34
    v_and_b32 v21, s63, v34
    v_lshlrev_b32 v22, 16, v35
    v_and_b32 v23, s63, v35
    v_add_f32 v40, v16, v17
    v_mul_f32 v41, v16, v16
    v_fmac_f32 v41, v17, v17
    v_add_f32 v40, v40, v18
    v_fmac_f32 v41, v18, v18
    v_add_f32 v40, v40, v19
    v_fmac_f32 v41, v19, v19
    v_add_f32 v40, v40, v20
    v_fmac_f32 v41, v20, v20
    v_add_f32 v40, v40, v21
    v_fmac_f32 v41, v21, v21
    v_add_f32 v40, v40, v22
    v_fmac_f32 v41, v22, v22
    v_add_f32 v40, v40, v23
    v_fmac_f32 v41, v23, v23
    v_mov_b32 v149, v40
    s_nop 1
    v_permlane16_swap_b32 v40, v149
    v_add_f32 v40, v40, v149
    v_mov_b32 v149, v40
    s_nop 1
    v_permlane32_swap_b32 v40, v149
    v_add_f32 v40, v40, v149
    v_mov_b32 v150, v41
    s_nop 1
    v_permlane16_swap_b32 v41, v150
    v_add_f32 v41, v41, v150
    v_mov_b32 v150, v41
    s_nop 1
    v_permlane32_swap_b32 v41, v150
    v_add_f32 v41, v41, v150
    s_mov_b64 exec, 0xffff
    buffer_store_dwordx2 v[40:41], v151, s[52:55], s39 offen
    s_mov_b64 exec, 1
    s_waitcnt vmcnt(0)
    buffer_store_dword v153, v154, s[56:59], s15 offen
    v_mov_b32 v154, 163712
    ds_add_u32 v154, v153 offset:16
    s_mov_b64 exec, -1
    s_nop 0
CA_SKIP:
    s_waitcnt lgkmcnt(0)
    s_cmp_eq_u32 s11, 1
    s_cbranch_scc1 CA_FAST
    s_mov_b32 s10, 0
    s_branch C_DISP
CA_FAST:
    s_cmp_ge_u32 s5, 28
    s_cbranch_scc1 C_PF28
CB_ENTRY:
    s_and_b32 s6, s5, 1
    s_lshl_b32 s9, s4, 1
    s_add_u32 s6, s6, s9
    s_lshr_b32 s7, s5, 1
    s_and_b32 s11, s3, 1
    s_lshr_b32 s12, s3, 1
    s_mov_b32 s44, s26
    s_and_b32 s45, s27, 0xffff
    s_mov_b32 s46, 3584
    s_mov_b32 s47, 0x20000
    v_lshlrev_b32 v124, 3, v3
    s_lshl_b32 s13, s7, 8
    s_lshl_b32 s9, s3, 5
    s_add_u32 s13, s13, s9
    buffer_load_dwordx2 v[120:121], v124, s[44:47], s13 offen
    s_xor_b32 s13, s13, 32
    buffer_load_dwordx2 v[122:123], v124, s[44:47], s13 offen
    s_lshl_b32 s9, s11, 12
    v_add_u32 v5, s9, v4
    v_add_u32 v6, 65536, v5
    v_add_u32 v7, 131072, v5
    v_lshrrev_b32 v8, 2, v2
    v_lshl_add_u32 v8, v3, 2, v8
    v_and_b32 v9, 7, v8
    v_lshlrev_b32 v8, 8, v8
    v_lshl_add_u32 v8, v9, 5, v8
    v_and_b32 v9, 3, v1
    v_lshl_add_u32 v8, v9, 3, v8
    s_lshl_b32 s9, s3, 5
    v_xor_b32 v8, s9, v8
    v_add_u32 v9, 65536, v8
    v_add_u32 v10, 131072, v8
    v_xor_b32 v11, 32, v8
    v_add_u32 v12, 65536, v11
    v_add_u32 v13, 131072, v11
    v_mov_b32 v16, 0x3f803f80
    v_mov_b32 v17, 0x3f803f80
    v_mov_b32 v18, 0x3f803f80
    v_mov_b32 v19, 0x3f803f80
    s_lshl_b32 s9, s3, 6
    s_add_u32 s9, s9, 156672
    v_lshl_add_u32 v20, v3, 4, s9
    v_xor_b32 v21, 64, v20
    s_lshl_b32 s38, s6, 7
    s_lshl_b32 s9, s11, 6
    s_add_u32 s38, s38, s9
    s_add_u32 s40, s36, 4194304
    s_addc_u32 s41, s37, 0
    s_and_b32 s41, s41, 0xffff
    s_mov_b32 s42, 7340032
    s_mov_b32 s43, 0x20000
    s_lshr_b32 s13, s38, 4
    s_mul_i32 s13, s13, 56
    s_lshl_b32 s9, s7, 2
    s_add_u32 s13, s13, s9
    s_add_u32 s13, s13, s12
    s_lshl_b32 s13, s13, 10
    v_lshrrev_b32 v126, 3, v1
    v_mul_u32_u24 v126, 57344, v126
    v_and_b32 v127, 7, v1
    v_lshl_add_u32 v126, v127, 7, v126
    s_lshl_b32 s9, s11, 9
    s_add_u32 s9, s9, 155648
    v_lshl_add_u32 v125, v2, 3, s9
    s_mov_b32 s52, s28
    s_and_b32 s53, s29, 0xffff
    s_mov_b32 s54, 1835008
    s_mov_b32 s55, 0x20000
    s_mul_i32 s14, s3, 28
    s_add_u32 s14, s14, s5
    s_lshl_b32 s14, s14, 13
    v_lshlrev_b32 v128, 7, v1
    s_barrier
    ds_read_b64_tr_b16 v[40:41], v10
    ds_read_b64_tr_b16 v[42:43], v10 offset:4096
    ds_read_b64_tr_b16 v[44:45], v13
    ds_read_b64_tr_b16 v[46:47], v13 offset:4096
    ds_read_b128 v[24:27], v5 offset:40960
    ds_read_b128 v[28:31], v5 offset:41984
    ds_read_b128 v[32:35], v5 offset:43008
    ds_read_b128 v[36:39], v5 offset:44032
    s_waitcnt lgkmcnt(0)
    s_barrier
    v_mfma_f32_16x16x32_bf16 v[104:107], v[40:43], v[16:19], 0
    ds_read_b64_tr_b16 v[64:65], v10 offset:8192
    ds_read_b64_tr_b16 v[66:67], v10 offset:12288
    v_mfma_f32_16x16x32_bf16 v[72:75], v[40:43], v[24:27], 0
    ds_read_b64_tr_b16 v[68:69], v13 offset:8192
    ds_read_b64_tr_b16 v[70:71], v13 offset:12288
    v_mfma_f32_16x16x32_bf16 v[80:83], v[40:43], v[28:31], 0
    ds_read_b128 v[48:51], v5 offset:8192
    ds_read_b128 v[52:55], v5 offset:9216
    v_mfma_f32_16x16x32_bf16 v[88:91], v[40:43], v[32:35], 0
    ds_read_b128 v[56:59], v5 offset:10240
    ds_read_b128 v[60:63], v5 offset:11264
    v_mfma_f32_16x16x32_bf16 v[96:99], v[40:43], v[36:39], 0
    v_mfma_f32_16x16x32_bf16 v[76:79], v[44:47], v[24:27], 0
    v_mfma_f32_16x16x32_bf16 v[84:87], v[44:47], v[28:31], 0
    v_mfma_f32_16x16x32_bf16 v[92:95], v[44:47], v[32:35], 0
    v_mfma_f32_16x16x32_bf16 v[100:103], v[44:47], v[36:39], 0
    s_waitcnt lgkmcnt(0)
    s_barrier
    v_mfma_f32_16x16x32_bf16 v[104:107], v[64:67], v[16:19], v[104:107]
    ds_read_b64_tr_b16 v[40:41], v10 offset:16384
    ds_read_b64_tr_b16 v[42:43], v10 offset:20480
    v_mfma_f32_16x16x32_bf16 v[72:75], v[64:67], v[48:51], v[72:75]
    ds_read_b64_tr_b16 v[44:45], v13 offset:16384
    ds_read_b64_tr_b16 v[46:47], v13 offset:20480
    v_mfma_f32_16x16x32_bf16 v[80:83], v[64:67], v[52:55], v[80:83]
    ds_read_b128 v[24:27], v5 offset:24576
    ds_read_b128 v[28:31], v5 offset:25600
    v_mfma_f32_16x16x32_bf16 v[88:91], v[64:67], v[56:59], v[88:91]
    ds_read_b128 v[32:35], v5 offset:26624
    ds_read_b128 v[36:39], v5 offset:27648
    v_mfma_f32_16x16x32_bf16 v[96:99], v[64:67], v[60:63], v[96:99]
    v_mfma_f32_16x16x32_bf16 v[76:79], v[68:71], v[48:51], v[76:79]
    v_mfma_f32_16x16x32_bf16 v[84:87], v[68:71], v[52:55], v[84:87]
    v_mfma_f32_16x16x32_bf16 v[92:95], v[68:71], v[56:59], v[92:95]
    v_mfma_f32_16x16x32_bf16 v[100:103], v[68:71], v[60:63], v[100:103]
    s_waitcnt lgkmcnt(0)
    s_barrier
    v_mfma_f32_16x16x32_bf16 v[104:107], v[40:43], v[16:19], v[104:107]
    ds_read_b64_tr_b16 v[64:65], v8
    ds_read_b64_tr_b16 v[66:67], v8 offset:4096
    v_mfma_f32_16x16x32_bf16 v[72:75], v[40:43], v[24:27], v[72:75]
    ds_read_b64_tr_b16 v[68:69], v11
    ds_read_b64_tr_b16 v[70:71], v11 offset:4096
    v_mfma_f32_16x16x32_bf16 v[80:83], v[40:43], v[28:31], v[80:83]
    ds_read_b128 v[48:51], v5 offset:57344
    ds_read_b128 v[52:55], v5 offset:58368
    v_mfma_f32_16x16x32_bf16 v[88:91], v[40:43], v[32:35], v[88:91]
    ds_read_b128 v[56:59], v5 offset:59392
    ds_read_b128 v[60:63], v5 offset:60416
    v_mfma_f32_16x16x32_bf16 v[96:99], v[40:43], v[36:39], v[96:99]
    v_mfma_f32_16x16x32_bf16 v[76:79], v[44:47], v[24:27], v[76:79]
    v_mfma_f32_16x16x32_bf16 v[84:87], v[44:47], v[28:31], v[84:87]
    v_mfma_f32_16x16x32_bf16 v[92:95], v[44:47], v[32:35], v[92:95]
    v_mfma_f32_16x16x32_bf16 v[100:103], v[44:47], v[36:39], v[100:103]
    s_waitcnt lgkmcnt(0)
    s_barrier
    v_mfma_f32_16x16x32_bf16 v[104:107], v[64:67], v[16:19], v[104:107]
    ds_read_b64_tr_b16 v[40:41], v8 offset:16384
    ds_read_b64_tr_b16 v[42:43], v8 offset:20480
    v_mfma_f32_16x16x32_bf16 v[72:75], v[64:67], v[48:51], v[72:75]
    ds_read_b64_tr_b16 v[44:45], v11 offset:16384
    ds_read_b64_tr_b16 v[46:47], v11 offset:20480
    v_mfma_f32_16x16x32_bf16 v[80:83], v[64:67], v[52:55], v[80:83]
    ds_read_b128 v[24:27], v6 offset:24576
    ds_read_b128 v[28:31], v6 offset:25600
    v_mfma_f32_16x16x32_bf16 v[88:91], v[64:67], v[56:59], v[88:91]
    ds_read_b128 v[32:35], v6 offset:26624
    ds_read_b128 v[36:39], v6 offset:27648
    v_mfma_f32_16x16x32_bf16 v[96:99], v[64:67], v[60:63], v[96:99]
    v_mfma_f32_16x16x32_bf16 v[76:79], v[68:71], v[48:51], v[76:79]
    v_mfma_f32_16x16x32_bf16 v[84:87], v[68:71], v[52:55], v[84:87]
    v_mfma_f32_16x16x32_bf16 v[92:95], v[68:71], v[56:59], v[92:95]
    v_mfma_f32_16x16x32_bf16 v[100:103], v[68:71], v[60:63], v[100:103]
    s_waitcnt lgkmcnt(0)
    s_barrier
    v_mfma_f32_16x16x32_bf16 v[104:107], v[40:43], v[16:19], v[104:107]
    ds_read_b64_tr_b16 v[64:65], v8 offset:32768
    ds_read_b64_tr_b16 v[66:67], v8 offset:36864
    v_mfma_f32_16x16x32_bf16 v[72:75], v[40:43], v[24:27], v[72:75]
    ds_read_b64_tr_b16 v[68:69], v11 offset:32768
    ds_read_b64_tr_b16 v[70:71], v11 offset:36864
    v_mfma_f32_16x16x32_bf16 v[80:83], v[40:43], v[28:31], v[80:83]
    ds_read_b128 v[48:51], v6
    ds_read_b128 v[52:55], v6 offset:1024
    v_mfma_f32_16x16x32_bf16 v[88:91], v[40:43], v[32:35], v[88:91]
    ds_read_b128 v[56:59], v6 offset:2048
    ds_read_b128 v[60:63], v6 offset:3072
    v_mfma_f32_16x16x32_bf16 v[96:99], v[40:43], v[36:39], v[96:99]
    v_mfma_f32_16x16x32_bf16 v[76:79], v[44:47], v[24:27], v[76:79]
    v_mfma_f32_16x16x32_bf16 v[84:87], v[44:47], v[28:31], v[84:87]
    v_mfma_f32_16x16x32_bf16 v[92:95], v[44:47], v[32:35], v[92:95]
    v_mfma_f32_16x16x32_bf16 v[100:103], v[44:47], v[36:39], v[100:103]
    s_waitcnt lgkmcnt(0)
    s_barrier
    v_mfma_f32_16x16x32_bf16 v[104:107], v[64:67], v[16:19], v[104:107]
    ds_read_b64_tr_b16 v[40:41], v8 offset:49152
    ds_read_b64_tr_b16 v[42:43], v8 offset:53248
    v_mfma_f32_16x16x32_bf16 v[72:75], v[64:67], v[48:51], v[72:75]
    ds_read_b64_tr_b16 v[44:45], v11 offset:49152
    ds_read_b64_tr_b16 v[46:47], v11 offset:53248
    v_mfma_f32_16x16x32_bf16 v[80:83], v[64:67], v[52:55], v[80:83]
    ds_read_b128 v[24:27], v5 offset:40960
    ds_read_b128 v[28:31], v5 offset:41984
    v_mfma_f32_16x16x32_bf16 v[88:91], v[64:67], v[56:59], v[88:91]
    ds_read_b128 v[32:35], v5 offset:43008
    ds_read_b128 v[36:39], v5 offset:44032
    v_mfma_f32_16x16x32_bf16 v[96:99], v[64:67], v[60:63], v[96:99]
    v_mfma_f32_16x16x32_bf16 v[76:79], v[68:71], v[48:51], v[76:79]
    v_mfma_f32_16x16x32_bf16 v[84:87], v[68:71], v[52:55], v[84:87]
    v_mfma_f32_16x16x32_bf16 v[92:95], v[68:71], v[56:59], v[92:95]
    v_mfma_f32_16x16x32_bf16 v[100:103], v[68:71], v[60:63], v[100:103]
    s_waitcnt lgkmcnt(0)
    s_barrier
    v_mfma_f32_16x16x32_bf16 v[104:107], v[40:43], v[16:19], v[104:107]
    ds_read_b64_tr_b16 v[64:65], v9 offset:16384
    ds_read_b64_tr_b16 v[66:67], v9 offset:20480
    v_mfma_f32_16x16x32_bf16 v[72:75], v[40:43], v[24:27], v[72:75]
    ds_read_b64_tr_b16 v[68:69], v12 offset:16384
    ds_read_b64_tr_b16 v[70:71], v12 offset:20480
    v_mfma_f32_16x16x32_bf16 v[80:83], v[40:43], v[28:31], v[80:83]
    ds_read_b128 v[48:51], v5 offset:8192
    ds_read_b128 v[52:55], v5 offset:9216
    v_mfma_f32_16x16x32_bf16 v[88:91], v[40:43], v[32:35], v[88:91]
    ds_read_b128 v[56:59], v5 offset:10240
    ds_read_b128 v[60:63], v5 offset:11264
    v_mfma_f32_16x16x32_bf16 v[96:99], v[40:43], v[36:39], v[96:99]
    v_mfma_f32_16x16x32_bf16 v[76:79], v[44:47], v[24:27], v[76:79]
    v_mfma_f32_16x16x32_bf16 v[84:87], v[44:47], v[28:31], v[84:87]
    v_mfma_f32_16x16x32_bf16 v[92:95], v[44:47], v[32:35], v[92:95]
    v_mfma_f32_16x16x32_bf16 v[100:103], v[44:47], v[36:39], v[100:103]
    s_waitcnt lgkmcnt(0)
    s_barrier
    v_mfma_f32_16x16x32_bf16 v[104:107], v[64:67], v[16:19], v[104:107]
    ds_read_b64_tr_b16 v[40:41], v9 offset:57344
    ds_read_b64_tr_b16 v[42:43], v9 offset:61440
    v_mfma_f32_16x16x32_bf16 v[72:75], v[64:67], v[48:51], v[72:75]
    ds_read_b64_tr_b16 v[44:45], v12 offset:57344
    ds_read_b64_tr_b16 v[46:47], v12 offset:61440
    v_mfma_f32_16x16x32_bf16 v[80:83], v[64:67], v[52:55], v[80:83]
    ds_read_b128 v[24:27], v5 offset:24576
    ds_read_b128 v[28:31], v5 offset:25600
    v_mfma_f32_16x16x32_bf16 v[88:91], v[64:67], v[56:59], v[88:91]
    ds_read_b128 v[32:35], v5 offset:26624
    ds_read_b128 v[36:39], v5 offset:27648
    v_mfma_f32_16x16x32_bf16 v[96:99], v[64:67], v[60:63], v[96:99]
    v_mfma_f32_16x16x32_bf16 v[76:79], v[68:71], v[48:51], v[76:79]
    v_mfma_f32_16x16x32_bf16 v[84:87], v[68:71], v[52:55], v[84:87]
    v_mfma_f32_16x16x32_bf16 v[92:95], v[68:71], v[56:59], v[92:95]
    v_mfma_f32_16x16x32_bf16 v[100:103], v[68:71], v[60:63], v[100:103]
    s_waitcnt lgkmcnt(0)
    s_barrier
    v_mfma_f32_16x16x32_bf16 v[104:107], v[40:43], v[16:19], v[104:107]
    ds_read_b64_tr_b16 v[64:65], v10
    ds_read_b64_tr_b16 v[66:67], v10 offset:4096
    v_mfma_f32_16x16x32_bf16 v[72:75], v[40:43], v[24:27], v[72:75]
    ds_read_b64_tr_b16 v[68:69], v13
    ds_read_b64_tr_b16 v[70:71], v13 offset:4096
    v_mfma_f32_16x16x32_bf16 v[80:83], v[40:43], v[28:31], v[80:83]
    ds_read_b128 v[48:51], v5 offset:57344
    ds_read_b128 v[52:55], v5 offset:58368
    v_mfma_f32_16x16x32_bf16 v[88:91], v[40:43], v[32:35], v[88:91]
    ds_read_b128 v[56:59], v5 offset:59392
    ds_read_b128 v[60:63], v5 offset:60416
    v_mfma_f32_16x16x32_bf16 v[96:99], v[40:43], v[36:39], v[96:99]
    v_mfma_f32_16x16x32_bf16 v[76:79], v[44:47], v[24:27], v[76:79]
    v_mfma_f32_16x16x32_bf16 v[84:87], v[44:47], v[28:31], v[84:87]
    v_mfma_f32_16x16x32_bf16 v[92:95], v[44:47], v[32:35], v[92:95]
    v_mfma_f32_16x16x32_bf16 v[100:103], v[44:47], v[36:39], v[100:103]
    s_waitcnt lgkmcnt(0)
    s_barrier
    v_mfma_f32_16x16x32_bf16 v[104:107], v[64:67], v[16:19], v[104:107]
    ds_read_b64_tr_b16 v[40:41], v9 offset:8192
    ds_read_b64_tr_b16 v[42:43], v9 offset:12288
    v_mfma_f32_16x16x32_bf16 v[72:75], v[64:67], v[48:51], v[72:75]
    ds_read_b64_tr_b16 v[44:45], v12 offset:8192
    ds_read_b64_tr_b16 v[46:47], v12 offset:12288
    v_mfma_f32_16x16x32_bf16 v[80:83], v[64:67], v[52:55], v[80:83]
    ds_read_b128 v[24:27], v6 offset:24576
    ds_read_b128 v[28:31], v6 offset:25600
    v_mfma_f32_16x16x32_bf16 v[88:91], v[64:67], v[56:59], v[88:91]
    ds_read_b128 v[32:35], v6 offset:26624
    ds_read_b128 v[36:39], v6 offset:27648
    v_mfma_f32_16x16x32_bf16 v[96:99], v[64:67], v[60:63], v[96:99]
    v_mfma_f32_16x16x32_bf16 v[76:79], v[68:71], v[48:51], v[76:79]
    v_mfma_f32_16x16x32_bf16 v[84:87], v[68:71], v[52:55], v[84:87]
    v_mfma_f32_16x16x32_bf16 v[92:95], v[68:71], v[56:59], v[92:95]
    v_mfma_f32_16x16x32_bf16 v[100:103], v[68:71], v[60:63], v[100:103]
    s_waitcnt lgkmcnt(0)
    s_barrier
    v_mfma_f32_16x16x32_bf16 v[104:107], v[40:43], v[16:19], v[104:107]
    ds_read_b64_tr_b16 v[64:65], v9 offset:32768
    ds_read_b64_tr_b16 v[66:67], v9 offset:36864
    v_mfma_f32_16x16x32_bf16 v[72:75], v[40:43], v[24:27], v[72:75]
    ds_read_b64_tr_b16 v[68:69], v12 offset:32768
    ds_read_b64_tr_b16 v[70:71], v12 offset:36864
    v_mfma_f32_16x16x32_bf16 v[80:83], v[40:43], v[28:31], v[80:83]
    ds_read_b128 v[48:51], v5 offset:32768
    ds_read_b128 v[52:55], v5 offset:33792
    v_mfma_f32_16x16x32_bf16 v[88:91], v[40:43], v[32:35], v[88:91]
    ds_read_b128 v[56:59], v5 offset:34816
    ds_read_b128 v[60:63], v5 offset:35840
    v_mfma_f32_16x16x32_bf16 v[96:99], v[40:43], v[36:39], v[96:99]
    v_mfma_f32_16x16x32_bf16 v[76:79], v[44:47], v[24:27], v[76:79]
    v_mfma_f32_16x16x32_bf16 v[84:87], v[44:47], v[28:31], v[84:87]
    v_mfma_f32_16x16x32_bf16 v[92:95], v[44:47], v[32:35], v[92:95]
    v_mfma_f32_16x16x32_bf16 v[100:103], v[44:47], v[36:39], v[100:103]
    ds_read_b64 v[112:113], v125
    ds_read_b64 v[114:115], v125 offset:128
    ds_read_b64 v[116:117], v125 offset:256
    ds_read_b64 v[118:119], v125 offset:384
    s_waitcnt lgkmcnt(4)
    s_barrier
    v_mfma_f32_16x16x32_bf16 v[104:107], v[64:67], v[16:19], v[104:107]
    ds_read_b64_tr_b16 v[40:41], v8 offset:16384
    ds_read_b64_tr_b16 v[42:43], v8 offset:20480
    v_mfma_f32_16x16x32_bf16 v[72:75], v[64:67], v[48:51], v[72:75]
    ds_read_b64_tr_b16 v[44:45], v11 offset:16384
    ds_read_b64_tr_b16 v[46:47], v11 offset:20480
    v_mfma_f32_16x16x32_bf16 v[80:83], v[64:67], v[52:55], v[80:83]
    ds_read_b128 v[24:27], v6 offset:40960
    ds_read_b128 v[28:31], v6 offset:41984
    v_mfma_f32_16x16x32_bf16 v[88:91], v[64:67], v[56:59], v[88:91]
    ds_read_b128 v[32:35], v6 offset:43008
    ds_read_b128 v[36:39], v6 offset:44032
    v_mfma_f32_16x16x32_bf16 v[96:99], v[64:67], v[60:63], v[96:99]
    v_mfma_f32_16x16x32_bf16 v[76:79], v[68:71], v[48:51], v[76:79]
    v_mfma_f32_16x16x32_bf16 v[84:87], v[68:71], v[52:55], v[84:87]
    v_mfma_f32_16x16x32_bf16 v[92:95], v[68:71], v[56:59], v[92:95]
    v_mfma_f32_16x16x32_bf16 v[100:103], v[68:71], v[60:63], v[100:103]
    s_waitcnt lgkmcnt(0)
    s_barrier
    v_mfma_f32_16x16x32_bf16 v[104:107], v[40:43], v[16:19], v[104:107]
    ds_read_b64_tr_b16 v[64:65], v9
    ds_read_b64_tr_b16 v[66:67], v9 offset:4096
    v_mfma_f32_16x16x32_bf16 v[72:75], v[40:43], v[24:27], v[72:75]
    ds_read_b64_tr_b16 v[68:69], v12
    ds_read_b64_tr_b16 v[70:71], v12 offset:4096
    v_mfma_f32_16x16x32_bf16 v[80:83], v[40:43], v[28:31], v[80:83]
    ds_read_b128 v[48:51], v7 offset:8192
    ds_read_b128 v[52:55], v7 offset:9216
    v_mfma_f32_16x16x32_bf16 v[88:91], v[40:43], v[32:35], v[88:91]
    ds_read_b128 v[56:59], v7 offset:10240
    ds_read_b128 v[60:63], v7 offset:11264
    v_mfma_f32_16x16x32_bf16 v[96:99], v[40:43], v[36:39], v[96:99]
    v_mfma_f32_16x16x32_bf16 v[76:79], v[44:47], v[24:27], v[76:79]
    v_mfma_f32_16x16x32_bf16 v[84:87], v[44:47], v[28:31], v[84:87]
    v_mfma_f32_16x16x32_bf16 v[92:95], v[44:47], v[32:35], v[92:95]
    v_mfma_f32_16x16x32_bf16 v[100:103], v[44:47], v[36:39], v[100:103]
    s_waitcnt lgkmcnt(0)
    s_barrier
    v_mfma_f32_16x16x32_bf16 v[104:107], v[64:67], v[16:19], v[104:107]
    ds_read_b64_tr_b16 v[40:41], v9 offset:49152
    ds_read_b64_tr_b16 v[42:43], v9 offset:53248
    v_mfma_f32_16x16x32_bf16 v[72:75], v[64:67], v[48:51], v[72:75]
    ds_read_b64_tr_b16 v[44:45], v12 offset:49152
    ds_read_b64_tr_b16 v[46:47], v12 offset:53248
    v_mfma_f32_16x16x32_bf16 v[80:83], v[64:67], v[52:55], v[80:83]
    ds_read_b128 v[24:27], v5 offset:24576
    ds_read_b128 v[28:31], v5 offset:25600
    v_mfma_f32_16x16x32_bf16 v[88:91], v[64:67], v[56:59], v[88:91]
    ds_read_b128 v[32:35], v5 offset:26624
    ds_read_b128 v[36:39], v5 offset:27648
    v_mfma_f32_16x16x32_bf16 v[96:99], v[64:67], v[60:63], v[96:99]
    v_mfma_f32_16x16x32_bf16 v[76:79], v[68:71], v[48:51], v[76:79]
    v_mfma_f32_16x16x32_bf16 v[84:87], v[68:71], v[52:55], v[84:87]
    v_mfma_f32_16x16x32_bf16 v[92:95], v[68:71], v[56:59], v[92:95]
    v_mfma_f32_16x16x32_bf16 v[100:103], v[68:71], v[60:63], v[100:103]
    s_waitcnt lgkmcnt(0)
    s_barrier
    v_mfma_f32_16x16x32_bf16 v[104:107], v[40:43], v[16:19], v[104:107]
    ds_read_b64_tr_b16 v[64:65], v10 offset:16384
    ds_read_b64_tr_b16 v[66:67], v10 offset:20480
    v_mfma_f32_16x16x32_bf16 v[72:75], v[40:43], v[24:27], v[72:75]
    ds_read_b64_tr_b16 v[68:69], v13 offset:16384
    ds_read_b64_tr_b16 v[70:71], v13 offset:20480
    v_mfma_f32_16x16x32_bf16 v[80:83], v[40:43], v[28:31], v[80:83]
    ds_read_b128 v[48:51], v5 offset:57344
    ds_read_b128 v[52:55], v5 offset:58368
    v_mfma_f32_16x16x32_bf16 v[88:91], v[40:43], v[32:35], v[88:91]
    ds_read_b128 v[56:59], v5 offset:59392
    ds_read_b128 v[60:63], v5 offset:60416
    v_mfma_f32_16x16x32_bf16 v[96:99], v[40:43], v[36:39], v[96:99]
    v_mfma_f32_16x16x32_bf16 v[76:79], v[44:47], v[24:27], v[76:79]
    v_mfma_f32_16x16x32_bf16 v[84:87], v[44:47], v[28:31], v[84:87]
    v_mfma_f32_16x16x32_bf16 v[92:95], v[44:47], v[32:35], v[92:95]
    v_mfma_f32_16x16x32_bf16 v[100:103], v[44:47], v[36:39], v[100:103]
    s_waitcnt lgkmcnt(0)
    v_mfma_f32_16x16x32_bf16 v[104:107], v[64:67], v[16:19], v[104:107]
    v_mfma_f32_16x16x32_bf16 v[72:75], v[64:67], v[48:51], v[72:75]
    v_mfma_f32_16x16x32_bf16 v[80:83], v[64:67], v[52:55], v[80:83]
    v_mfma_f32_16x16x32_bf16 v[88:91], v[64:67], v[56:59], v[88:91]
    s_mov_b32 exec_lo, 0x10001
    s_mov_b32 exec_hi, 0x10001
    s_nop 2
    ds_write_b128 v20, v[104:107]
    s_mov_b64 exec, -1
    v_lshrrev_b32 v6, 2, v2
    v_lshl_add_u32 v8, v3, 2, v6
    v_bfe_u32 v7, v8, 1, 2
    v_lshlrev_b32 v8, 7, v8
    v_lshl_add_u32 v8, v7, 5, v8
    v_and_b32 v7, 3, v1
    v_lshl_add_u32 v8, v7, 3, v8
    s_and_b32 s9, s3, 3
    s_mul_i32 s9, s9, 40960
    v_add_u32 v8, s9, v8
    s_lshr_b32 s9, s3, 2
    s_lshl_b32 s9, s9, 6
    v_xor_b32 v8, s9, v8
    v_xor_b32 v9, 32, v8
    v_mfma_f32_16x16x32_bf16 v[96:99], v[64:67], v[60:63], v[96:99]
    v_mfma_f32_16x16x32_bf16 v[76:79], v[68:71], v[48:51], v[76:79]
    v_mfma_f32_16x16x32_bf16 v[84:87], v[68:71], v[52:55], v[84:87]
    v_mfma_f32_16x16x32_bf16 v[92:95], v[68:71], v[56:59], v[92:95]
    v_mfma_f32_16x16x32_bf16 v[100:103], v[68:71], v[60:63], v[100:103]
    s_waitcnt lgkmcnt(0)
    s_barrier
    ds_read_b128 v[108:111], v21
    ds_read_b64_tr_b16 v[24:25], v8
    ds_read_b64_tr_b16 v[26:27], v8 offset:2048
    ds_read_b64_tr_b16 v[28:29], v9
    ds_read_b64_tr_b16 v[30:31], v9 offset:2048
    ds_read_b64_tr_b16 v[32:33], v8 offset:4096
    ds_read_b64_tr_b16 v[34:35], v8 offset:6144
    ds_read_b64_tr_b16 v[36:37], v9 offset:4096
    ds_read_b64_tr_b16 v[38:39], v9 offset:6144
    ds_read_b64_tr_b16 v[40:41], v8 offset:8192
    ds_read_b64_tr_b16 v[42:43], v8 offset:10240
    ds_read_b64_tr_b16 v[44:45], v9 offset:8192
    ds_read_b64_tr_b16 v[46:47], v9 offset:10240
    s_mov_b32 s39, 0xbdd2d3e8
    v_mov_b32 v132, 0xc0135761
    v_mov_b32 v133, 0xbdd2d3e8
    v_mov_b32 v134, 1.0
    v_mov_b32 v135, 1.0
    s_waitcnt vmcnt(0)
    v_lshlrev_b32 v124, 16, v120
    v_and_b32 v125, s63, v120
    v_lshlrev_b32 v126, 16, v121
    v_and_b32 v127, s63, v121
    v_lshlrev_b32 v128, 16, v122
    v_and_b32 v129, s63, v122
    v_lshlrev_b32 v130, 16, v123
    v_and_b32 v131, s63, v123
    s_lshl_b32 s15, s4, 12
    s_and_b32 s9, s5, 1
    s_lshl_b32 s9, s9, 9
    s_add_u32 s15, s15, s9
    s_lshl_b32 s9, s7, 5
    s_add_u32 s15, s15, s9
    s_lshl_b32 s9, s3, 2
    s_add_u32 s15, s15, s9
    v_mov_b32 v14, 1
    v_mov_b32 v15, 0
    s_sub_u32 s9, 0, s11
    s_mov_b32 vcc_lo, s9
    s_mov_b32 vcc_hi, s9
    s_waitcnt lgkmcnt(8)
    ds_read_b64_tr_b16 v[48:49], v8 offset:12288
    ds_read_b64_tr_b16 v[50:51], v8 offset:14336
    ds_read_b64_tr_b16 v[52:53], v9 offset:12288
    ds_read_b64_tr_b16 v[54:55], v9 offset:14336
    v_pk_fma_f32 v[72:73], v[112:113], v[104:105], v[72:73] op_sel:[0,0,0] op_sel_hi:[0,1,1] neg_lo:[1,0,0] neg_hi:[1,0,0]
    v_pk_fma_f32 v[74:75], v[112:113], v[106:107], v[74:75] op_sel:[0,0,0] op_sel_hi:[0,1,1] neg_lo:[1,0,0] neg_hi:[1,0,0]
    v_pk_fma_f32 v[72:73], v[72:73], v[112:113], v[124:125] op_sel:[0,1,0] op_sel_hi:[1,1,1]
    v_pk_fma_f32 v[74:75], v[74:75], v[112:113], v[126:127] op_sel:[0,1,0] op_sel_hi:[1,1,1]
    v_pk_mul_f32 v[136:137], v[72:73], v[72:73]
    v_pk_mul_f32 v[138:139], v[74:75], v[74:75]
    v_pk_fma_f32 v[136:137], v[136:137], v[132:133], v[132:133] op_sel:[0,1,0] op_sel_hi:[1,1,0]
    v_pk_fma_f32 v[138:139], v[138:139], v[132:133], v[132:133] op_sel:[0,1,0] op_sel_hi:[1,1,0]
    v_pk_mul_f32 v[136:137], v[136:137], v[72:73]
    v_pk_mul_f32 v[138:139], v[138:139], v[74:75]
    v_exp_f32 v136, v136
    v_exp_f32 v137, v137
    v_exp_f32 v138, v138
    v_exp_f32 v139, v139
    v_pk_add_f32 v[136:137], v[136:137], v[134:135]
    v_pk_add_f32 v[138:139], v[138:139], v[134:135]
    v_rcp_f32 v136, v136
    v_rcp_f32 v137, v137
    v_rcp_f32 v138, v138
    v_rcp_f32 v139, v139
    v_pk_mul_f32 v[72:73], v[72:73], v[136:137]
    v_pk_mul_f32 v[74:75], v[74:75], v[138:139]
    v_cvt_pk_bf16_f32 v140, v72, v73
    v_cvt_pk_bf16_f32 v141, v74, v75
    v_pk_fma_f32 v[76:77], v[112:113], v[108:109], v[76:77] op_sel:[0,0,0] op_sel_hi:[0,1,1] neg_lo:[1,0,0] neg_hi:[1,0,0]
    v_pk_fma_f32 v[78:79], v[112:113], v[110:111], v[78:79] op_sel:[0,0,0] op_sel_hi:[0,1,1] neg_lo:[1,0,0] neg_hi:[1,0,0]
    v_pk_fma_f32 v[76:77], v[76:77], v[112:113], v[128:129] op_sel:[0,1,0] op_sel_hi:[1,1,1]
    v_pk_fma_f32 v[78:79], v[78:79], v[112:113], v[130:131] op_sel:[0,1,0] op_sel_hi:[1,1,1]
    v_pk_mul_f32 v[136:137], v[76:77], v[76:77]
    v_pk_mul_f32 v[138:139], v[78:79], v[78:79]
    v_pk_fma_f32 v[136:137], v[136:137], v[132:133], v[132:133] op_sel:[0,1,0] op_sel_hi:[1,1,0]
    v_pk_fma_f32 v[138:139], v[138:139], v[132:133], v[132:133] op_sel:[0,1,0] op_sel_hi:[1,1,0]
    v_pk_mul_f32 v[136:137], v[136:137], v[76:77]
    v_pk_mul_f32 v[138:139], v[138:139], v[78:79]
    v_exp_f32 v136, v136
    v_exp_f32 v137, v137
    v_exp_f32 v138, v138
    v_exp_f32 v139, v139
    v_pk_add_f32 v[136:137], v[136:137], v[134:135]
    v_pk_add_f32 v[138:139], v[138:139], v[134:135]
    v_rcp_f32 v136, v136
    v_rcp_f32 v137, v137
    v_rcp_f32 v138, v138
    v_rcp_f32 v139, v139
    v_pk_mul_f32 v[76:77], v[76:77], v[136:137]
    v_pk_mul_f32 v[78:79], v[78:79], v[138:139]
    v_cvt_pk_bf16_f32 v142, v76, v77
    v_cvt_pk_bf16_f32 v143, v78, v79
    s_cbranch_vccz CB_NS0
    v_swap_b32 v140, v142
    v_swap_b32 v141, v143
CB_NS0:
    buffer_store_dwordx4 v[140:143], v4, s[40:43], s13 offen sc1
    s_nop 0
    s_add_u32 s13, s13, 57344
    s_waitcnt lgkmcnt(0)
    s_barrier
    v_pk_fma_f32 v[80:81], v[114:115], v[104:105], v[80:81] op_sel:[0,0,0] op_sel_hi:[0,1,1] neg_lo:[1,0,0] neg_hi:[1,0,0]
    v_pk_fma_f32 v[82:83], v[114:115], v[106:107], v[82:83] op_sel:[0,0,0] op_sel_hi:[0,1,1] neg_lo:[1,0,0] neg_hi:[1,0,0]
    v_pk_fma_f32 v[80:81], v[80:81], v[114:115], v[124:125] op_sel:[0,1,0] op_sel_hi:[1,1,1]
    v_pk_fma_f32 v[82:83], v[82:83], v[114:115], v[126:127] op_sel:[0,1,0] op_sel_hi:[1,1,1]
    v_pk_mul_f32 v[136:137], v[80:81], v[80:81]
    v_pk_mul_f32 v[138:139], v[82:83], v[82:83]
    v_pk_fma_f32 v[136:137], v[136:137], v[132:133], v[132:133] op_sel:[0,1,0] op_sel_hi:[1,1,0]
    v_pk_fma_f32 v[138:139], v[138:139], v[132:133], v[132:133] op_sel:[0,1,0] op_sel_hi:[1,1,0]
    v_pk_mul_f32 v[136:137], v[136:137], v[80:81]
    v_pk_mul_f32 v[138:139], v[138:139], v[82:83]
    v_exp_f32 v136, v136
    v_exp_f32 v137, v137
    v_exp_f32 v138, v138
    v_exp_f32 v139, v139
    v_pk_add_f32 v[136:137], v[136:137], v[134:135]
    v_pk_add_f32 v[138:139], v[138:139], v[134:135]
    v_rcp_f32 v136, v136
    v_rcp_f32 v137, v137
    v_rcp_f32 v138, v138
    v_rcp_f32 v139, v139
    v_pk_mul_f32 v[80:81], v[80:81], v[136:137]
    v_pk_mul_f32 v[82:83], v[82:83], v[138:139]
    v_cvt_pk_bf16_f32 v144, v80, v81
    v_cvt_pk_bf16_f32 v145, v82, v83
    v_pk_fma_f32 v[84:85], v[114:115], v[108:109], v[84:85] op_sel:[0,0,0] op_sel_hi:[0,1,1] neg_lo:[1,0,0] neg_hi:[1,0,0]
    v_pk_fma_f32 v[86:87], v[114:115], v[110:111], v[86:87] op_sel:[0,0,0] op_sel_hi:[0,1,1] neg_lo:[1,0,0] neg_hi:[1,0,0]
    v_pk_fma_f32 v[84:85], v[84:85], v[114:115], v[128:129] op_sel:[0,1,0] op_sel_hi:[1,1,1]
    v_pk_fma_f32 v[86:87], v[86:87], v[114:115], v[130:131] op_sel:[0,1,0] op_sel_hi:[1,1,1]
    v_pk_mul_f32 v[136:137], v[84:85], v[84:85]
    v_pk_mul_f32 v[138:139], v[86:87], v[86:87]
    v_pk_fma_f32 v[136:137], v[136:137], v[132:133], v[132:133] op_sel:[0,1,0] op_sel_hi:[1,1,0]
    v_pk_fma_f32 v[138:139], v[138:139], v[132:133], v[132:133] op_sel:[0,1,0] op_sel_hi:[1,1,0]
    v_pk_mul_f32 v[136:137], v[136:137], v[84:85]
    v_pk_mul_f32 v[138:139], v[138:139], v[86:87]
    v_exp_f32 v136, v136
    v_exp_f32 v137, v137
    v_exp_f32 v138, v138
    v_exp_f32 v139, v139
    v_pk_add_f32 v[136:137], v[136:137], v[134:135]
    v_pk_add_f32 v[138:139], v[138:139], v[134:135]
    v_rcp_f32 v136, v136
PGS4:
    s_cbranch_execz PGS5
    v_rcp_f32 v137, v137
    v_rcp_f32 v138, v138
    v_rcp_f32 v139, v139
    v_pk_mul_f32 v[84:85], v[84:85], v[136:137]
    v_pk_mul_f32 v[86:87], v[86:87], v[138:139]
    v_cvt_pk_bf16_f32 v146, v84, v85
    v_cvt_pk_bf16_f32 v147, v86, v87
    s_cbranch_vccz CB_NS1
    v_swap_b32 v144, v146
    v_swap_b32 v145, v147
CB_NS1:
    buffer_store_dwordx4 v[144:147], v4, s[40:43], s13 offen sc1
    s_nop 0
    s_add_u32 s13, s13, 57344
    v_pk_fma_f32 v[88:89], v[116:117], v[104:105], v[88:89] op_sel:[0,0,0] op_sel_hi:[0,1,1] neg_lo:[1,0,0] neg_hi:[1,0,0]
    v_pk_fma_f32 v[90:91], v[116:117], v[106:107], v[90:91] op_sel:[0,0,0] op_sel_hi:[0,1,1] neg_lo:[1,0,0] neg_hi:[1,0,0]
    v_pk_fma_f32 v[88:89], v[88:89], v[116:117], v[124:125] op_sel:[0,1,0] op_sel_hi:[1,1,1]
    v_pk_fma_f32 v[90:91], v[90:91], v[116:117], v[126:127] op_sel:[0,1,0] op_sel_hi:[1,1,1]
    v_pk_mul_f32 v[136:137], v[88:89], v[88:89]
    v_pk_mul_f32 v[138:139], v[90:91], v[90:91]
    v_pk_fma_f32 v[136:137], v[136:137], v[132:133], v[132:133] op_sel:[0,1,0] op_sel_hi:[1,1,0]
    v_pk_fma_f32 v[138:139], v[138:139], v[132:133], v[132:133] op_sel:[0,1,0] op_sel_hi:[1,1,0]
    v_pk_mul_f32 v[136:137], v[136:137], v[88:89]
    v_pk_mul_f32 v[138:139], v[138:139], v[90:91]
    v_exp_f32 v136, v136
    v_exp_f32 v137, v137
    v_exp_f32 v138, v138
    v_exp_f32 v139, v139
    v_pk_add_f32 v[136:137], v[136:137], v[134:135]
    v_pk_add_f32 v[138:139], v[138:139], v[134:135]
    v_rcp_f32 v136, v136
    v_rcp_f32 v137, v137
    v_rcp_f32 v138, v138
    v_rcp_f32 v139, v139
    v_pk_mul_f32 v[88:89], v[88:89], v[136:137]
    v_pk_mul_f32 v[90:91], v[90:91], v[138:139]
    v_cvt_pk_bf16_f32 v140, v88, v89
    v_cvt_pk_bf16_f32 v141, v90, v91
    v_pk_fma_f32 v[92:93], v[116:117], v[108:109], v[92:93] op_sel:[0,0,0] op_sel_hi:[0,1,1] neg_lo:[1,0,0] neg_hi:[1,0,0]
    v_pk_fma_f32 v[94:95], v[116:117], v[110:111], v[94:95] op_sel:[0,0,0] op_sel_hi:[0,1,1] neg_lo:[1,0,0] neg_hi:[1,0,0]
    v_pk_fma_f32 v[92:93], v[92:93], v[116:117], v[128:129] op_sel:[0,1,0] op_sel_hi:[1,1,1]
    v_pk_fma_f32 v[94:95], v[94:95], v[116:117], v[130:131] op_sel:[0,1,0] op_sel_hi:[1,1,1]
    v_pk_mul_f32 v[136:137], v[92:93], v[92:93]
    v_pk_mul_f32 v[138:139], v[94:95], v[94:95]
    v_pk_fma_f32 v[136:137], v[136:137], v[132:133], v[132:133] op_sel:[0,1,0] op_sel_hi:[1,1,0]
    v_pk_fma_f32 v[138:139], v[138:139], v[132:133], v[132:133] op_sel:[0,1,0] op_sel_hi:[1,1,0]
    v_pk_mul_f32 v[136:137], v[136:137], v[92:93]
    v_pk_mul_f32 v[138:139], v[138:139], v[94:95]
    v_exp_f32 v136, v136
    v_exp_f32 v137, v137
    v_exp_f32 v138, v138
    v_exp_f32 v139, v139
    v_pk_add_f32 v[136:137], v[136:137], v[134:135]
    v_pk_add_f32 v[138:139], v[138:139], v[134:135]
    v_rcp_f32 v136, v136
    v_rcp_f32 v137, v137
    v_rcp_f32 v138, v138
    v_rcp_f32 v139, v139
    v_pk_mul_f32 v[92:93], v[92:93], v[136:137]
    v_pk_mul_f32 v[94:95], v[94:95], v[138:139]
    v_cvt_pk_bf16_f32 v142, v92, v93
    v_cvt_pk_bf16_f32 v143, v94, v95
    s_cbranch_vccz CB_NS2
    v_swap_b32 v140, v142
    v_swap_b32 v141, v143
CB_NS2:
    buffer_store_dwordx4 v[140:143], v4, s[40:43], s13 offen sc1
    s_nop 0
    s_add_u32 s13, s13, 57344
    v_pk_fma_f32 v[96:97], v[118:119], v[104:105], v[96:97] op_sel:[0,0,0] op_sel_hi:[0,1,1] neg_lo:[1,0,0] neg_hi:[1,0,0]
    v_pk_fma_f32 v[98:99], v[118:119], v[106:107], v[98:99] op_sel:[0,0,0] op_sel_hi:[0,1,1] neg_lo:[1,0,0] neg_hi:[1,0,0]
    v_pk_fma_f32 v[96:97], v[96:97], v[118:119], v[124:125] op_sel:[0,1,0] op_sel_hi:[1,1,1]
    v_pk_fma_f32 v[98:99], v[98:99], v[118:119], v[126:127] op_sel:[0,1,0] op_sel_hi:[1,1,1]
    v_pk_mul_f32 v[136:137], v[96:97], v[96:97]
    v_pk_mul_f32 v[138:139], v[98:99], v[98:99]
    v_pk_fma_f32 v[136:137], v[136:137], v[132:133], v[132:133] op_sel:[0,1,0] op_sel_hi:[1,1,0]
    v_pk_fma_f32 v[138:139], v[138:139], v[132:133], v[132:133] op_sel:[0,1,0] op_sel_hi:[1,1,0]
    v_pk_mul_f32 v[136:137], v[136:137], v[96:97]
    v_pk_mul_f32 v[138:139], v[138:139], v[98:99]
    v_exp_f32 v136, v136
    v_exp_f32 v137, v137
    v_exp_f32 v138, v138
    v_exp_f32 v139, v139
    v_pk_add_f32 v[136:137], v[136:137], v[134:135]
    v_pk_add_f32 v[138:139], v[138:139], v[134:135]
    v_rcp_f32 v136, v136
    v_rcp_f32 v137, v137
    v_rcp_f32 v138, v138
    v_rcp_f32 v139, v139
    v_pk_mul_f32 v[96:97], v[96:97], v[136:137]
    v_pk_mul_f32 v[98:99], v[98:99], v[138:139]
    v_cvt_pk_bf16_f32 v144, v96, v97
    v_cvt_pk_bf16_f32 v145, v98, v99
    v_pk_fma_f32 v[100:101], v[118:119], v[108:109], v[100:101] op_sel:[0,0,0] op_sel_hi:[0,1,1] neg_lo:[1,0,0] neg_hi:[1,0,0]
    v_pk_fma_f32 v[102:103], v[118:119], v[110:111], v[102:103] op_sel:[0,0,0] op_sel_hi:[0,1,1] neg_lo:[1,0,0] neg_hi:[1,0,0]
    v_pk_fma_f32 v[100:101], v[100:101], v[118:119], v[128:129] op_sel:[0,1,0] op_sel_hi:[1,1,1]
    v_pk_fma_f32 v[102:103], v[102:103], v[118:119], v[130:131] op_sel:[0,1,0] op_sel_hi:[1,1,1]
    v_pk_mul_f32 v[136:137], v[100:101], v[100:101]
    v_pk_mul_f32 v[138:139], v[102:103], v[102:103]
    v_pk_fma_f32 v[136:137], v[136:137], v[132:133], v[132:133] op_sel:[0,1,0] op_sel_hi:[1,1,0]
    v_pk_fma_f32 v[138:139], v[138:139], v[132:133], v[132:133] op_sel:[0,1,0] op_sel_hi:[1,1,0]
    v_pk_mul_f32 v[136:137], v[136:137], v[100:101]
    v_pk_mul_f32 v[138:139], v[138:139], v[102:103]
    v_exp_f32 v136, v136
    v_exp_f32 v137, v137
    v_exp_f32 v138, v138
    v_exp_f32 v139, v139
    v_pk_add_f32 v[136:137], v[136:137], v[134:135]
    v_pk_add_f32 v[138:139], v[138:139], v[134:135]
    v_rcp_f32 v136, v136
    v_rcp_f32 v137, v137
    v_rcp_f32 v138, v138
    v_rcp_f32 v139, v139
    v_pk_mul_f32 v[100:101], v[100:101], v[136:137]
    v_pk_mul_f32 v[102:103], v[102:103], v[138:139]
    v_cvt_pk_bf16_f32 v146, v100, v101
    v_cvt_pk_bf16_f32 v147, v102, v103
    s_cbranch_vccz CB_NS3
    v_swap_b32 v144, v146
    v_swap_b32 v145, v147
CB_NS3:
    buffer_store_dwordx4 v[144:147], v4, s[40:43], s13 offen sc1
    s_mov_b64 exec, 1
    s_waitcnt vmcnt(0)
    buffer_store_dword v14, v15, s[56:59], s15 offen offset:1024
    s_mov_b64 exec, -1
    s_cmp_eq_u32 s10, 0
    s_cbranch_scc1 C_DISP
CC_FAST:
    s_and_b32 s6, s5, 3
    s_lshl_b32 s9, s4, 2
    s_add_u32 s6, s6, s9
    s_lshr_b32 s7, s5, 2
    s_and_b32 s9, s3, 3
    s_mul_i32 s11, s9, 40960
    s_lshr_b32 s12, s3, 2
    s_lshr_b32 s38, s3, 1
    s_lshl_b32 s38, s38, 4
    s_lshl_b32 s13, s6, 6
    s_add_u32 s38, s38, s13
    v_add_u32 v12, s38, v2
    v_lshlrev_b32 v13, 10, v12
    v_lshl_add_u32 v13, v3, 3, v13
    v_lshlrev_b32 v14, 3, v3
    s_and_b32 s13, s3, 1
    s_lshl_b32 s14, s7, 1
    s_add_u32 s13, s13, s14
    s_lshl_b32 s14, s13, 6
    s_mov_b32 s44, s30
    s_and_b32 s45, s31, 0xffff
    s_mov_b32 s46, 1024
    s_mov_b32 s47, 0x20000
    s_mov_b32 s40, s32
    s_and_b32 s41, s33, 0xffff
    s_mov_b32 s42, 2097152
    s_mov_b32 s43, 0x20000
    s_add_u32 s15, s38, s13
    s_lshl_b32 s15, s15, 10
    buffer_load_dwordx2 v[20:21], v14, s[44:47], s14 offen
    buffer_load_dwordx2 v[22:23], v14, s[44:47], s14 offen offset:32
    v_add_u32 v5, s11, v4
    s_barrier
    ds_read_b64_tr_b16 v[56:57], v8 offset:16384
    ds_read_b64_tr_b16 v[58:59], v8 offset:18432
    ds_read_b64_tr_b16 v[60:61], v9 offset:16384
    ds_read_b64_tr_b16 v[62:63], v9 offset:18432
    ds_read_b64_tr_b16 v[64:65], v8 offset:20480
    ds_read_b64_tr_b16 v[66:67], v8 offset:22528
    ds_read_b64_tr_b16 v[68:69], v9 offset:20480
    ds_read_b64_tr_b16 v[70:71], v9 offset:22528
    ds_read_b64_tr_b16 v[136:137], v8 offset:24576
    ds_read_b64_tr_b16 v[138:139], v8 offset:26624
    ds_read_b64_tr_b16 v[140:141], v9 offset:24576
    ds_read_b64_tr_b16 v[142:143], v9 offset:26624
    s_waitcnt lgkmcnt(8)
    ds_read_b64_tr_b16 v[144:145], v8 offset:28672
    ds_read_b64_tr_b16 v[146:147], v8 offset:30720
    ds_read_b64_tr_b16 v[148:149], v9 offset:28672
    ds_read_b64_tr_b16 v[150:151], v9 offset:30720
    s_waitcnt lgkmcnt(0)
    s_barrier
    s_barrier
    buffer_load_dwordx4 v[16:19], v4, s[48:51], s15 offen sc1
    ds_read_b128 v[104:107], v5 offset:16384
    ds_read_b128 v[108:111], v5 offset:17408
    ds_read_b128 v[112:115], v5 offset:18432
    ds_read_b128 v[116:119], v5 offset:19456
    s_waitcnt lgkmcnt(0)
    s_barrier
    v_mfma_f32_16x16x32_bf16 v[72:75], v[24:27], v[104:107], 0
    ds_read_b128 v[120:123], v5 offset:20480
    ds_read_b128 v[124:127], v5 offset:21504
    v_mfma_f32_16x16x32_bf16 v[80:83], v[24:27], v[108:111], 0
    ds_read_b128 v[128:131], v5 offset:22528
    ds_read_b128 v[132:135], v5 offset:23552
    v_mfma_f32_16x16x32_bf16 v[88:91], v[24:27], v[112:115], 0
    v_mfma_f32_16x16x32_bf16 v[96:99], v[24:27], v[116:119], 0
    v_mfma_f32_16x16x32_bf16 v[76:79], v[28:31], v[104:107], 0
    v_mfma_f32_16x16x32_bf16 v[84:87], v[28:31], v[108:111], 0
    v_mfma_f32_16x16x32_bf16 v[92:95], v[28:31], v[112:115], 0
    v_mfma_f32_16x16x32_bf16 v[100:103], v[28:31], v[116:119], 0
    s_waitcnt lgkmcnt(0)
    s_barrier
    v_mfma_f32_16x16x32_bf16 v[72:75], v[32:35], v[120:123], v[72:75]
    ds_read_b128 v[104:107], v5 offset:24576
    ds_read_b128 v[108:111], v5 offset:25600
    v_mfma_f32_16x16x32_bf16 v[80:83], v[32:35], v[124:127], v[80:83]
    ds_read_b128 v[112:115], v5 offset:26624
    ds_read_b128 v[116:119], v5 offset:27648
    v_mfma_f32_16x16x32_bf16 v[88:91], v[32:35], v[128:131], v[88:91]
    v_mfma_f32_16x16x32_bf16 v[96:99], v[32:35], v[132:135], v[96:99]
    v_mfma_f32_16x16x32_bf16 v[76:79], v[36:39], v[120:123], v[76:79]
    v_mfma_f32_16x16x32_bf16 v[84:87], v[36:39], v[124:127], v[84:87]
    v_mfma_f32_16x16x32_bf16 v[92:95], v[36:39], v[128:131], v[92:95]
    v_mfma_f32_16x16x32_bf16 v[100:103], v[36:39], v[132:135], v[100:103]
    s_waitcnt lgkmcnt(0)
    s_barrier
    v_mfma_f32_16x16x32_bf16 v[72:75], v[40:43], v[104:107], v[72:75]
    ds_read_b128 v[120:123], v5 offset:28672
    ds_read_b128 v[124:127], v5 offset:29696
    v_mfma_f32_16x16x32_bf16 v[80:83], v[40:43], v[108:111], v[80:83]
    ds_read_b128 v[128:131], v5 offset:30720
    ds_read_b128 v[132:135], v5 offset:31744
    v_mfma_f32_16x16x32_bf16 v[88:91], v[40:43], v[112:115], v[88:91]
    v_mfma_f32_16x16x32_bf16 v[96:99], v[40:43], v[116:119], v[96:99]
    v_mfma_f32_16x16x32_bf16 v[76:79], v[44:47], v[104:107], v[76:79]
    v_mfma_f32_16x16x32_bf16 v[84:87], v[44:47], v[108:111], v[84:87]
    v_mfma_f32_16x16x32_bf16 v[92:95], v[44:47], v[112:115], v[92:95]
    v_mfma_f32_16x16x32_bf16 v[100:103], v[44:47], v[116:119], v[100:103]
    s_waitcnt lgkmcnt(0)
    s_barrier
    v_mfma_f32_16x16x32_bf16 v[72:75], v[48:51], v[120:123], v[72:75]
    ds_read_b128 v[104:107], v5 offset:16384
    ds_read_b128 v[108:111], v5 offset:17408
    v_mfma_f32_16x16x32_bf16 v[80:83], v[48:51], v[124:127], v[80:83]
    ds_read_b128 v[112:115], v5 offset:18432
    ds_read_b128 v[116:119], v5 offset:19456
    v_mfma_f32_16x16x32_bf16 v[88:91], v[48:51], v[128:131], v[88:91]
    v_mfma_f32_16x16x32_bf16 v[96:99], v[48:51], v[132:135], v[96:99]
    v_mfma_f32_16x16x32_bf16 v[76:79], v[52:55], v[120:123], v[76:79]
    v_mfma_f32_16x16x32_bf16 v[84:87], v[52:55], v[124:127], v[84:87]
    v_mfma_f32_16x16x32_bf16 v[92:95], v[52:55], v[128:131], v[92:95]
    v_mfma_f32_16x16x32_bf16 v[100:103], v[52:55], v[132:135], v[100:103]
    s_waitcnt lgkmcnt(0)
    s_barrier
    v_mfma_f32_16x16x32_bf16 v[72:75], v[56:59], v[104:107], v[72:75]
    ds_read_b128 v[120:123], v5 offset:20480
    ds_read_b128 v[124:127], v5 offset:21504
    v_mfma_f32_16x16x32_bf16 v[80:83], v[56:59], v[108:111], v[80:83]
    ds_read_b128 v[128:131], v5 offset:22528
    ds_read_b128 v[132:135], v5 offset:23552
    v_mfma_f32_16x16x32_bf16 v[88:91], v[56:59], v[112:115], v[88:91]
    v_mfma_f32_16x16x32_bf16 v[96:99], v[56:59], v[116:119], v[96:99]
    v_mfma_f32_16x16x32_bf16 v[76:79], v[60:63], v[104:107], v[76:79]
    v_mfma_f32_16x16x32_bf16 v[84:87], v[60:63], v[108:111], v[84:87]
    v_mfma_f32_16x16x32_bf16 v[92:95], v[60:63], v[112:115], v[92:95]
    v_mfma_f32_16x16x32_bf16 v[100:103], v[60:63], v[116:119], v[100:103]
    s_waitcnt lgkmcnt(0)
    s_barrier
    v_mfma_f32_16x16x32_bf16 v[72:75], v[64:67], v[120:123], v[72:75]
    ds_read_b128 v[104:107], v5 offset:24576
    ds_read_b128 v[108:111], v5 offset:25600
    v_mfma_f32_16x16x32_bf16 v[80:83], v[64:67], v[124:127], v[80:83]
    ds_read_b128 v[112:115], v5 offset:26624
    ds_read_b128 v[116:119], v5 offset:27648
    v_mfma_f32_16x16x32_bf16 v[88:91], v[64:67], v[128:131], v[88:91]
    v_mfma_f32_16x16x32_bf16 v[96:99], v[64:67], v[132:135], v[96:99]
    v_mfma_f32_16x16x32_bf16 v[76:79], v[68:71], v[120:123], v[76:79]
    v_mfma_f32_16x16x32_bf16 v[84:87], v[68:71], v[124:127], v[84:87]
    v_mfma_f32_16x16x32_bf16 v[92:95], v[68:71], v[128:131], v[92:95]
    v_mfma_f32_16x16x32_bf16 v[100:103], v[68:71], v[132:135], v[100:103]
    s_waitcnt lgkmcnt(0)
    s_barrier
    v_mfma_f32_16x16x32_bf16 v[72:75], v[136:139], v[104:107], v[72:75]
    ds_read_b128 v[120:123], v5 offset:28672
    ds_read_b128 v[124:127], v5 offset:29696
    v_mfma_f32_16x16x32_bf16 v[80:83], v[136:139], v[108:111], v[80:83]
    ds_read_b128 v[128:131], v5 offset:30720
    ds_read_b128 v[132:135], v5 offset:31744
    v_mfma_f32_16x16x32_bf16 v[88:91], v[136:139], v[112:115], v[88:91]
    v_mfma_f32_16x16x32_bf16 v[96:99], v[136:139], v[116:119], v[96:99]
    v_mfma_f32_16x16x32_bf16 v[76:79], v[140:143], v[104:107], v[76:79]
    v_mfma_f32_16x16x32_bf16 v[84:87], v[140:143], v[108:111], v[84:87]
    v_mfma_f32_16x16x32_bf16 v[92:95], v[140:143], v[112:115], v[92:95]
    v_mfma_f32_16x16x32_bf16 v[100:103], v[140:143], v[116:119], v[100:103]
    s_waitcnt lgkmcnt(0)
    s_barrier
    v_mfma_f32_16x16x32_bf16 v[72:75], v[144:147], v[120:123], v[72:75]
    ds_read_b64_tr_b16 v[24:25], v8
    ds_read_b64_tr_b16 v[26:27], v8 offset:2048
    v_mfma_f32_16x16x32_bf16 v[80:83], v[144:147], v[124:127], v[80:83]
    ds_read_b64_tr_b16 v[28:29], v9
    ds_read_b64_tr_b16 v[30:31], v9 offset:2048
    v_mfma_f32_16x16x32_bf16 v[88:91], v[144:147], v[128:131], v[88:91]
    ds_read_b128 v[104:107], v5 offset:16384
    ds_read_b128 v[108:111], v5 offset:17408
    v_mfma_f32_16x16x32_bf16 v[96:99], v[144:147], v[132:135], v[96:99]
    ds_read_b128 v[112:115], v5 offset:18432
    ds_read_b128 v[116:119], v5 offset:19456
    v_mfma_f32_16x16x32_bf16 v[76:79], v[148:151], v[120:123], v[76:79]
    v_mfma_f32_16x16x32_bf16 v[84:87], v[148:151], v[124:127], v[84:87]
    v_mfma_f32_16x16x32_bf16 v[92:95], v[148:151], v[128:131], v[92:95]
    v_mfma_f32_16x16x32_bf16 v[100:103], v[148:151], v[132:135], v[100:103]
    s_waitcnt lgkmcnt(0)
    s_barrier
    v_mfma_f32_16x16x32_bf16 v[72:75], v[24:27], v[104:107], v[72:75]
    ds_read_b64_tr_b16 v[32:33], v8 offset:4096
    ds_read_b64_tr_b16 v[34:35], v8 offset:6144
    v_mfma_f32_16x16x32_bf16 v[80:83], v[24:27], v[108:111], v[80:83]
    ds_read_b64_tr_b16 v[36:37], v9 offset:4096
    ds_read_b64_tr_b16 v[38:39], v9 offset:6144
    v_mfma_f32_16x16x32_bf16 v[88:91], v[24:27], v[112:115], v[88:91]
    ds_read_b128 v[120:123], v5 offset:20480
    ds_read_b128 v[124:127], v5 offset:21504
    v_mfma_f32_16x16x32_bf16 v[96:99], v[24:27], v[116:119], v[96:99]
    ds_read_b128 v[128:131], v5 offset:22528
    ds_read_b128 v[132:135], v5 offset:23552
    v_mfma_f32_16x16x32_bf16 v[76:79], v[28:31], v[104:107], v[76:79]
    v_mfma_f32_16x16x32_bf16 v[84:87], v[28:31], v[108:111], v[84:87]
    v_mfma_f32_16x16x32_bf16 v[92:95], v[28:31], v[112:115], v[92:95]
    v_mfma_f32_16x16x32_bf16 v[100:103], v[28:31], v[116:119], v[100:103]
    s_waitcnt lgkmcnt(0)
    s_barrier
    v_mfma_f32_16x16x32_bf16 v[72:75], v[32:35], v[120:123], v[72:75]
    ds_read_b64_tr_b16 v[24:25], v8 offset:8192
    ds_read_b64_tr_b16 v[26:27], v8 offset:10240
    v_mfma_f32_16x16x32_bf16 v[80:83], v[32:35], v[124:127], v[80:83]
    ds_read_b64_tr_b16 v[28:29], v9 offset:8192
    ds_read_b64_tr_b16 v[30:31], v9 offset:10240
    v_mfma_f32_16x16x32_bf16 v[88:91], v[32:35], v[128:131], v[88:91]
    ds_read_b128 v[104:107], v5 offset:24576
    ds_read_b128 v[108:111], v5 offset:25600
    v_mfma_f32_16x16x32_bf16 v[96:99], v[32:35], v[132:135], v[96:99]
    ds_read_b128 v[112:115], v5 offset:26624
    ds_read_b128 v[116:119], v5 offset:27648
    v_mfma_f32_16x16x32_bf16 v[76:79], v[36:39], v[120:123], v[76:79]
    v_mfma_f32_16x16x32_bf16 v[84:87], v[36:39], v[124:127], v[84:87]
    v_mfma_f32_16x16x32_bf16 v[92:95], v[36:39], v[128:131], v[92:95]
    v_mfma_f32_16x16x32_bf16 v[100:103], v[36:39], v[132:135], v[100:103]
    s_waitcnt lgkmcnt(0)
    s_barrier
    v_mfma_f32_16x16x32_bf16 v[72:75], v[24:27], v[104:107], v[72:75]
    ds_read_b64_tr_b16 v[32:33], v8 offset:12288
    ds_read_b64_tr_b16 v[34:35], v8 offset:14336
    v_mfma_f32_16x16x32_bf16 v[80:83], v[24:27], v[108:111], v[80:83]
    ds_read_b64_tr_b16 v[36:37], v9 offset:12288
    ds_read_b64_tr_b16 v[38:39], v9 offset:14336
    v_mfma_f32_16x16x32_bf16 v[88:91], v[24:27], v[112:115], v[88:91]
    ds_read_b128 v[120:123], v5 offset:28672
    ds_read_b128 v[124:127], v5 offset:29696
    v_mfma_f32_16x16x32_bf16 v[96:99], v[24:27], v[116:119], v[96:99]
    ds_read_b128 v[128:131], v5 offset:30720
    ds_read_b128 v[132:135], v5 offset:31744
    v_mfma_f32_16x16x32_bf16 v[76:79], v[28:31], v[104:107], v[76:79]
    v_mfma_f32_16x16x32_bf16 v[84:87], v[28:31], v[108:111], v[84:87]
    v_mfma_f32_16x16x32_bf16 v[92:95], v[28:31], v[112:115], v[92:95]
    v_mfma_f32_16x16x32_bf16 v[100:103], v[28:31], v[116:119], v[100:103]
    s_waitcnt lgkmcnt(0)
    s_barrier
    v_mfma_f32_16x16x32_bf16 v[72:75], v[32:35], v[120:123], v[72:75]
    ds_read_b64_tr_b16 v[24:25], v8 offset:32768
    ds_read_b64_tr_b16 v[26:27], v8 offset:34816
    v_mfma_f32_16x16x32_bf16 v[80:83], v[32:35], v[124:127], v[80:83]
    ds_read_b64_tr_b16 v[28:29], v9 offset:32768
    ds_read_b64_tr_b16 v[30:31], v9 offset:34816
    v_mfma_f32_16x16x32_bf16 v[88:91], v[32:35], v[128:131], v[88:91]
    ds_read_b128 v[104:107], v5 offset:16384
    ds_read_b128 v[108:111], v5 offset:17408
    v_mfma_f32_16x16x32_bf16 v[96:99], v[32:35], v[132:135], v[96:99]
    ds_read_b128 v[112:115], v5 offset:18432
    ds_read_b128 v[116:119], v5 offset:19456
    v_mfma_f32_16x16x32_bf16 v[76:79], v[36:39], v[120:123], v[76:79]
    v_mfma_f32_16x16x32_bf16 v[84:87], v[36:39], v[124:127], v[84:87]
    v_mfma_f32_16x16x32_bf16 v[92:95], v[36:39], v[128:131], v[92:95]
    v_mfma_f32_16x16x32_bf16 v[100:103], v[36:39], v[132:135], v[100:103]
    s_waitcnt lgkmcnt(0)
    s_barrier
    v_mfma_f32_16x16x32_bf16 v[72:75], v[24:27], v[104:107], v[72:75]
    ds_read_b64_tr_b16 v[32:33], v8 offset:36864
    ds_read_b64_tr_b16 v[34:35], v8 offset:38912
    v_mfma_f32_16x16x32_bf16 v[80:83], v[24:27], v[108:111], v[80:83]
    ds_read_b64_tr_b16 v[36:37], v9 offset:36864
    ds_read_b64_tr_b16 v[38:39], v9 offset:38912
    v_mfma_f32_16x16x32_bf16 v[88:91], v[24:27], v[112:115], v[88:91]
    ds_read_b128 v[120:123], v5 offset:20480
    ds_read_b128 v[124:127], v5 offset:21504
    v_mfma_f32_16x16x32_bf16 v[96:99], v[24:27], v[116:119], v[96:99]
    ds_read_b128 v[128:131], v5 offset:22528
    ds_read_b128 v[132:135], v5 offset:23552
    v_mfma_f32_16x16x32_bf16 v[76:79], v[28:31], v[104:107], v[76:79]
    v_mfma_f32_16x16x32_bf16 v[84:87], v[28:31], v[108:111], v[84:87]
    v_mfma_f32_16x16x32_bf16 v[92:95], v[28:31], v[112:115], v[92:95]
    v_mfma_f32_16x16x32_bf16 v[100:103], v[28:31], v[116:119], v[100:103]
    s_waitcnt lgkmcnt(0)
    v_mfma_f32_16x16x32_bf16 v[72:75], v[32:35], v[120:123], v[72:75]
    v_mfma_f32_16x16x32_bf16 v[80:83], v[32:35], v[124:127], v[80:83]
    v_mfma_f32_16x16x32_bf16 v[88:91], v[32:35], v[128:131], v[88:91]
    v_mfma_f32_16x16x32_bf16 v[96:99], v[32:35], v[132:135], v[96:99]
    v_mfma_f32_16x16x32_bf16 v[76:79], v[36:39], v[120:123], v[76:79]
    v_mfma_f32_16x16x32_bf16 v[84:87], v[36:39], v[124:127], v[84:87]
    v_mfma_f32_16x16x32_bf16 v[92:95], v[36:39], v[128:131], v[92:95]
    v_mfma_f32_16x16x32_bf16 v[100:103], v[36:39], v[132:135], v[100:103]
    s_lshl_b32 s9, s12, 11
    v_add_u32 v5, s9, v5
    ds_write_b128 v5, v[72:75]
    s_nop 1
    ds_write_b128 v5, v[76:79] offset:1024
    ds_write_b128 v5, v[80:83] offset:4096
    ds_write_b128 v5, v[84:87] offset:5120
    ds_write_b128 v5, v[88:91] offset:8192
    ds_write_b128 v5, v[92:95] offset:9216
    ds_write_b128 v5, v[96:99] offset:12288
    ds_write_b128 v5, v[100:103] offset:13312
    s_lshl_b32 s9, s3, 11
    v_add_u32 v104, s9, v4
    v_add_u32 v105, 81920, v104
    v_mov_b32 v108, 28672
    s_waitcnt lgkmcnt(0)
    s_barrier
    ds_read_b32 v108, v108
    ds_read_b128 v[24:27], v104
    ds_read_b128 v[28:31], v104 offset:1024
    ds_read_b128 v[32:35], v104 offset:40960
    ds_read_b128 v[36:39], v104 offset:41984
    ds_read_b128 v[40:43], v105
    ds_read_b128 v[44:47], v105 offset:1024
    ds_read_b128 v[48:51], v105 offset:40960
    ds_read_b128 v[52:55], v105 offset:41984
    s_waitcnt vmcnt(0)
    v_lshlrev_b32 v56, 16, v20
    v_and_b32 v57, s63, v20
    v_lshlrev_b32 v64, 16, v16
    v_and_b32 v65, s63, v16
    v_lshlrev_b32 v58, 16, v21
    v_and_b32 v59, s63, v21
    v_lshlrev_b32 v66, 16, v17
    v_and_b32 v67, s63, v17
    v_lshlrev_b32 v60, 16, v22
    v_and_b32 v61, s63, v22
    v_lshlrev_b32 v68, 16, v18
    v_and_b32 v69, s63, v18
    v_lshlrev_b32 v62, 16, v23
    v_and_b32 v63, s63, v23
    v_lshlrev_b32 v70, 16, v19
    v_and_b32 v71, s63, v19
    s_waitcnt lgkmcnt(4)
    v_readfirstlane_b32 s11, v108
    v_add_f32 v24, v24, v32
    v_add_f32 v25, v25, v33
    v_add_f32 v26, v26, v34
    v_add_f32 v27, v27, v35
    v_add_f32 v28, v28, v36
    v_add_f32 v29, v29, v37
    v_add_f32 v30, v30, v38
    v_add_f32 v31, v31, v39
    s_waitcnt lgkmcnt(0)
    v_add_f32 v40, v40, v48
    v_add_f32 v41, v41, v49
    v_add_f32 v42, v42, v50
    v_add_f32 v43, v43, v51
    v_add_f32 v44, v44, v52
    v_add_f32 v45, v45, v53
    v_add_f32 v46, v46, v54
    v_add_f32 v47, v47, v55
    v_add_f32 v24, v24, v40
    v_add_f32 v25, v25, v41
    v_add_f32 v26, v26, v42
    v_add_f32 v27, v27, v43
    v_add_f32 v28, v28, v44
    v_add_f32 v29, v29, v45
    v_add_f32 v30, v30, v46
    v_add_f32 v31, v31, v47
    v_cvt_pk_bf16_f32 v106, v24, v25
    v_lshlrev_b32 v24, 16, v106
    v_and_b32 v25, s63, v106
    v_cvt_pk_bf16_f32 v106, v26, v27
    v_lshlrev_b32 v26, 16, v106
    v_and_b32 v27, s63, v106
    v_cvt_pk_bf16_f32 v106, v28, v29
    v_lshlrev_b32 v28, 16, v106
    v_and_b32 v29, s63, v106
    v_cvt_pk_bf16_f32 v106, v30, v31
    v_lshlrev_b32 v30, 16, v106
    v_and_b32 v31, s63, v106
    v_add_f32 v24, v24, v56
    v_add_f32 v25, v25, v57
    v_add_f32 v26, v26, v58
    v_add_f32 v27, v27, v59
    v_add_f32 v28, v28, v60
    v_add_f32 v29, v29, v61
    v_add_f32 v30, v30, v62
    v_add_f32 v31, v31, v63
    v_cvt_pk_bf16_f32 v106, v24, v25
    v_lshlrev_b32 v24, 16, v106
    v_and_b32 v25, s63, v106
    v_cvt_pk_bf16_f32 v106, v26, v27
    v_lshlrev_b32 v26, 16, v106
    v_and_b32 v27, s63, v106
    v_cvt_pk_bf16_f32 v106, v28, v29
    v_lshlrev_b32 v28, 16, v106
    v_and_b32 v29, s63, v106
    v_cvt_pk_bf16_f32 v106, v30, v31
    v_lshlrev_b32 v30, 16, v106
    v_and_b32 v31, s63, v106
    v_add_f32 v24, v24, v64
    v_add_f32 v25, v25, v65
    v_add_f32 v26, v26, v66
    v_add_f32 v27, v27, v67
    v_add_f32 v28, v28, v68
    v_add_f32 v29, v29, v69
    v_add_f32 v30, v30, v70
    v_add_f32 v31, v31, v71
    v_cvt_pk_bf16_f32 v16, v24, v25
    v_cvt_pk_bf16_f32 v17, v26, v27
    v_cvt_pk_bf16_f32 v18, v28, v29
    v_cvt_pk_bf16_f32 v19, v30, v31
    buffer_store_dwordx2 v[16:17], v13, s[40:43], s14 offen
    buffer_store_dwordx2 v[18:19], v13, s[40:43], s14 offen offset:32
    s_cmp_eq_u32 s11, 0
    s_cbranch_scc1 C_DISP0
    s_endpgm
C_DISP0:
    s_mov_b32 s10, 0
C_DISP:
    s_waitcnt vmcnt(0)
    s_barrier
    v_mov_b32 v5, 163776
    ds_read_b32 v5, v5 offset:4
    s_waitcnt lgkmcnt(0)
    s_barrier
    v_readfirstlane_b32 s9, v5
    s_bfe_u32 s5, s9, 0x80008
    s_bfe_u32 s4, s9, 0x80010
    s_and_b32 s9, s9, 255
    s_cmp_eq_u32 s9, 0
    s_nop 0
    s_cbranch_scc1 CA_ENTRY
    s_cmp_eq_u32 s9, 1
    s_cbranch_scc1 CB_ENTRY
    s_cmp_eq_u32 s9, 2
    s_cbranch_scc1 CC_ENTRY
    s_endpgm
CC_ENTRY:
    v_lshrrev_b32 v6, 2, v2
    v_lshl_add_u32 v8, v3, 2, v6
    v_bfe_u32 v7, v8, 1, 2
    v_lshlrev_b32 v8, 7, v8
    v_lshl_add_u32 v8, v7, 5, v8
    v_and_b32 v7, 3, v1
    v_lshl_add_u32 v8, v7, 3, v8
    s_and_b32 s9, s3, 3
    s_mul_i32 s9, s9, 40960
    v_add_u32 v8, s9, v8
    s_lshr_b32 s9, s3, 2
    s_lshl_b32 s9, s9, 6
    v_xor_b32 v8, s9, v8
    v_xor_b32 v9, 32, v8
    s_barrier
    ds_read_b64_tr_b16 v[24:25], v8
    ds_read_b64_tr_b16 v[26:27], v8 offset:2048
    ds_read_b64_tr_b16 v[28:29], v9
    ds_read_b64_tr_b16 v[30:31], v9 offset:2048
    ds_read_b64_tr_b16 v[32:33], v8 offset:4096
    ds_read_b64_tr_b16 v[34:35], v8 offset:6144
    ds_read_b64_tr_b16 v[36:37], v9 offset:4096
    ds_read_b64_tr_b16 v[38:39], v9 offset:6144
    ds_read_b64_tr_b16 v[40:41], v8 offset:8192
    ds_read_b64_tr_b16 v[42:43], v8 offset:10240
    ds_read_b64_tr_b16 v[44:45], v9 offset:8192
    ds_read_b64_tr_b16 v[46:47], v9 offset:10240
    s_waitcnt lgkmcnt(0)
    ds_read_b64_tr_b16 v[48:49], v8 offset:12288
    ds_read_b64_tr_b16 v[50:51], v8 offset:14336
    ds_read_b64_tr_b16 v[52:53], v9 offset:12288
    ds_read_b64_tr_b16 v[54:55], v9 offset:14336
    s_waitcnt lgkmcnt(0)
    s_barrier
    s_branch CC_FAST
C_PF28:
    s_barrier
    s_mov_b32 s44, s28
    s_and_b32 s45, s29, 0xffff
    s_mov_b32 s46, 1835008
    s_mov_b32 s47, 0x20000
    s_sub_u32 s9, s5, 28
    s_lshl_b32 s9, s9, 2
    s_and_b32 s11, s3, 3
    s_add_u32 s9, s9, s11
    s_lshr_b32 s11, s3, 2
    s_mul_i32 s11, s11, 112
    s_add_u32 s9, s9, s11
    s_lshl_b32 s9, s9, 13
    v_lshlrev_b32 v5, 7, v1
    s_add_u32 s11, s9, 0
    buffer_load_dword v24, v5, s[44:47], s11 offen
    s_add_u32 s11, s9, 131072
    buffer_load_dword v25, v5, s[44:47], s11 offen
    s_add_u32 s11, s9, 262144
    buffer_load_dword v26, v5, s[44:47], s11 offen
    s_add_u32 s11, s9, 393216
    buffer_load_dword v27, v5, s[44:47], s11 offen
    s_add_u32 s11, s9, 524288
    buffer_load_dword v28, v5, s[44:47], s11 offen
    s_add_u32 s11, s9, 655360
    buffer_load_dword v29, v5, s[44:47], s11 offen
    s_add_u32 s11, s9, 786432
    buffer_load_dword v30, v5, s[44:47], s11 offen
    s_waitcnt vmcnt(0)
    s_branch CC_ENTRY
KF_LOADER:
    s_sub_u32 s62, s3, 8
    s_getreg_b32 s4, hwreg(HW_REG_XCC_ID, 0, 3)
    s_lshr_b32 s5, s2, 3
    s_mov_b32 s10, 1
    s_mov_b32 s63, 0xffff0000
    s_getreg_b32 s8, hwreg(HW_REG_XCC_ID, 0, 4)
    s_lshr_b32 s69, s8, 1
    s_lshl_b32 s69, s69, 12
    s_and_b32 s9, s8, 1
    s_lshl_b32 s9, s9, 7
    s_add_u32 s69, s69, s9
    s_add_u32 s69, s69, 2176
    s_add_u32 s8, s8, 1
    v_lshrrev_b32 v5, 3, v1
    v_mul_u32_u24 v5, 1024, v5
    v_bfe_u32 v6, v1, 1, 2
    v_bfe_u32 v7, v1, 4, 2
    v_xor_b32 v6, v6, v7
    v_lshl_add_u32 v5, v6, 5, v5
    v_and_b32 v6, 1, v1
    v_lshl_add_u32 v5, v6, 4, v5
    v_mul_u32_u24 v8, 3584, v3
    v_and_b32 v6, 1, v1
    v_lshl_add_u32 v8, v6, 4, v8
    v_bfe_u32 v6, v1, 1, 3
    v_xor_b32 v6, v6, v3
    v_xor_b32 v7, 4, v6
    v_lshl_add_u32 v6, v6, 5, v8
    v_lshl_add_u32 v7, v7, 5, v8
    v_lshlrev_b32 v9, 3, v1
    v_mov_b32 v10, 163776
    v_mov_b32 v11, 0
    s_mov_b32 s64, 0
    s_mov_b32 s65, 0
    s_mov_b32 s66, 0
    s_mov_b32 s67, 0
    s_waitcnt lgkmcnt(0)
    s_add_u32 s56, s36, 15728640
    s_addc_u32 s57, s37, 0
PGS5:
    s_cbranch_execz PGS6
    s_and_b32 s57, s57, 0xffff
    s_mov_b32 s58, 131072
    s_mov_b32 s59, 0x20000
LA_ENTRY:
    s_and_b32 s6, s5, 3
    s_lshl_b32 s9, s4, 2
    s_add_u32 s6, s6, s9
    s_lshr_b32 s7, s5, 2
    s_lshl_b32 s9, s62, 2
    v_add_u32 v15, s9, v10
    s_mov_b32 s44, s20
    s_and_b32 s45, s21, 0xffff
    s_mov_b32 s46, 524288
    s_mov_b32 s47, 0x20000
    s_lshl_b32 s11, s62, 14
    s_lshl_b32 s12, s62, 17
    s_lshl_b32 s9, s7, 7
    s_add_u32 s12, s12, s9
    s_add_u32 s40, s36, 14155776
    s_addc_u32 s41, s37, 0
    s_and_b32 s41, s41, 0xffff
    s_mov_b32 s42, 40960
    s_mov_b32 s43, 0x20000
    s_cmp_eq_u32 s62, 0
    s_cbranch_scc1 LA_HELPER
LA_WSPa:
    ds_read_b32 v26, v15 offset:16
    s_waitcnt lgkmcnt(0)
    v_readfirstlane_b32 s9, v26
    s_cmp_lt_u32 s9, 3
    s_nop 3
    s_cbranch_scc1 LA_WSPa
    s_add_u32 s15, s12, 0
    s_add_u32 m0, s11, 0
    s_nop 0
    buffer_load_dwordx4 v5, s[44:47], s15 offen lds
    s_add_u32 s15, s12, 8192
    s_add_u32 m0, s11, 1024
    s_nop 0
    buffer_load_dwordx4 v5, s[44:47], s15 offen lds
    s_add_u32 s15, s12, 16384
    s_add_u32 m0, s11, 2048
    s_nop 0
    buffer_load_dwordx4 v5, s[44:47], s15 offen lds
    s_add_u32 s15, s12, 24576
    s_add_u32 m0, s11, 3072
    s_nop 0
    buffer_load_dwordx4 v5, s[44:47], s15 offen lds
    s_add_u32 s15, s12, 32768
    s_add_u32 m0, s11, 4096
    s_nop 0
    buffer_load_dwordx4 v5, s[44:47], s15 offen lds
    s_add_u32 s15, s12, 40960
    s_add_u32 m0, s11, 5120
    s_nop 0
    buffer_load_dwordx4 v5, s[44:47], s15 offen lds
    s_add_u32 s15, s12, 49152
    s_add_u32 m0, s11, 6144
    s_nop 0
    buffer_load_dwordx4 v5, s[44:47], s15 offen lds
    s_add_u32 s15, s12, 57344
    s_add_u32 m0, s11, 7168
    s_nop 0
    buffer_load_dwordx4 v5, s[44:47], s15 offen lds
    s_add_u32 s15, s12, 65536
    s_add_u32 m0, s11, 8192
    s_nop 0
    buffer_load_dwordx4 v5, s[44:47], s15 offen lds
    s_add_u32 s15, s12, 73728
    s_add_u32 m0, s11, 9216
    s_nop 0
    buffer_load_dwordx4 v5, s[44:47], s15 offen lds
    s_add_u32 s15, s12, 81920
    s_add_u32 m0, s11, 10240
    s_nop 0
    buffer_load_dwordx4 v5, s[44:47], s15 offen lds
    s_add_u32 s15, s12, 90112
    s_add_u32 m0, s11, 11264
    s_nop 0
    buffer_load_dwordx4 v5, s[44:47], s15 offen lds
    s_waitcnt vmcnt(8)
    v_mov_b32 v16, 1
    ds_write_b32 v15, v16 offset:32
    s_add_u32 s15, s12, 98304
    s_add_u32 m0, s11, 12288
    s_nop 0
    buffer_load_dwordx4 v5, s[44:47], s15 offen lds
    s_add_u32 s15, s12, 106496
    s_add_u32 m0, s11, 13312
    s_nop 0
    buffer_load_dwordx4 v5, s[44:47], s15 offen lds
    s_add_u32 s15, s12, 114688
    s_add_u32 m0, s11, 14336
    s_nop 0
    buffer_load_dwordx4 v5, s[44:47], s15 offen lds
    s_add_u32 s15, s12, 122880
    s_add_u32 m0, s11, 15360
    s_nop 0
    buffer_load_dwordx4 v5, s[44:47], s15 offen lds
    s_waitcnt vmcnt(8)
    v_mov_b32 v17, 2
    ds_write_b32 v15, v17 offset:32
    s_waitcnt vmcnt(4)
    v_mov_b32 v18, 3
    ds_write_b32 v15, v18 offset:32
    s_waitcnt vmcnt(0)
    v_mov_b32 v19, 4
    ds_write_b32 v15, v19 offset:32
    s_nop 1
    s_branch LA_JOIN
LA_HELPER:
    s_lshl_b32 s13, s4, 12
    s_add_u32 s13, s13, 2048
    s_lshl_b32 s9, s4, 2
    s_add_u32 s14, s69, s9
    s_lshl_b32 s9, 1, s5
    v_mov_b32 v20, s8
    v_mov_b32 v21, 0
    v_mov_b32 v22, s9
    s_mov_b64 exec, 1
    buffer_atomic_cmpswap v[20:21], v11, s[56:59], s13 offen sc0
    buffer_atomic_or v22, v11, s[56:59], s14 offen sc0
    s_mov_b64 exec, 0xffff
    v_lshlrev_b32 v24, 7, v1
    s_lshl_b32 s9, s4, 12
    buffer_load_dword v25, v24, s[56:59], s9 offen
    s_mov_b64 exec, -1
LA_WSPb:
    ds_read_b32 v26, v15 offset:16
    s_waitcnt lgkmcnt(0)
    v_readfirstlane_b32 s9, v26
    s_cmp_lt_u32 s9, 3
    s_nop 3
    s_cbranch_scc1 LA_WSPb
    s_add_u32 s15, s12, 0
    s_add_u32 m0, s11, 0
    s_nop 0
    buffer_load_dwordx4 v5, s[44:47], s15 offen lds
    s_add_u32 s15, s12, 8192
    s_add_u32 m0, s11, 1024
    s_nop 0
    buffer_load_dwordx4 v5, s[44:47], s15 offen lds
    s_add_u32 s15, s12, 16384
    s_add_u32 m0, s11, 2048
    s_nop 0
    buffer_load_dwordx4 v5, s[44:47], s15 offen lds
    s_add_u32 s15, s12, 24576
    s_add_u32 m0, s11, 3072
    s_nop 0
    buffer_load_dwordx4 v5, s[44:47], s15 offen lds
    s_add_u32 s15, s12, 32768
    s_add_u32 m0, s11, 4096
    s_nop 0
    buffer_load_dwordx4 v5, s[44:47], s15 offen lds
    s_add_u32 s15, s12, 40960
    s_add_u32 m0, s11, 5120
    s_nop 0
    buffer_load_dwordx4 v5, s[44:47], s15 offen lds
    s_add_u32 s15, s12, 49152
    s_add_u32 m0, s11, 6144
    s_nop 0
    buffer_load_dwordx4 v5, s[44:47], s15 offen lds
    s_add_u32 s15, s12, 57344
    s_add_u32 m0, s11, 7168
    s_nop 0
    buffer_load_dwordx4 v5, s[44:47], s15 offen lds
    s_add_u32 s15, s12, 65536
    s_add_u32 m0, s11, 8192
    s_nop 0
    buffer_load_dwordx4 v5, s[44:47], s15 offen lds
    s_add_u32 s15, s12, 73728
    s_add_u32 m0, s11, 9216
    s_nop 0
    buffer_load_dwordx4 v5, s[44:47], s15 offen lds
    s_add_u32 s15, s12, 81920
    s_add_u32 m0, s11, 10240
    s_nop 0
    buffer_load_dwordx4 v5, s[44:47], s15 offen lds
    s_add_u32 s15, s12, 90112
    s_add_u32 m0, s11, 11264
    s_nop 0
    buffer_load_dwordx4 v5, s[44:47], s15 offen lds
    s_waitcnt vmcnt(8)
    v_mov_b32 v16, 1
    ds_write_b32 v15, v16 offset:32
    s_add_u32 s15, s12, 98304
    s_add_u32 m0, s11, 12288
    s_nop 0
    buffer_load_dwordx4 v5, s[44:47], s15 offen lds
    s_add_u32 s15, s12, 106496
    s_add_u32 m0, s11, 13312
    s_nop 0
    buffer_load_dwordx4 v5, s[44:47], s15 offen lds
    s_add_u32 s15, s12, 114688
    s_add_u32 m0, s11, 14336
    s_nop 0
    buffer_load_dwordx4 v5, s[44:47], s15 offen lds
    s_add_u32 s15, s12, 122880
    s_add_u32 m0, s11, 15360
    s_nop 0
    buffer_load_dwordx4 v5, s[44:47], s15 offen lds
    s_waitcnt vmcnt(8)
    v_mov_b32 v17, 2
    ds_write_b32 v15, v17 offset:32
    s_waitcnt vmcnt(4)
    v_mov_b32 v18, 3
    ds_write_b32 v15, v18 offset:32
    s_waitcnt vmcnt(0)
    v_mov_b32 v19, 4
    ds_write_b32 v15, v19 offset:32
    buffer_load_dword v23, v11, s[56:59], s14 offen sc1
    s_waitcnt vmcnt(0)
    v_readfirstlane_b32 s11, v20
    v_readfirstlane_b32 s12, v22
    v_readfirstlane_b32 s13, v23
    s_mov_b32 s15, 0
    s_mov_b32 s66, 3
    s_cmp_eq_u32 s11, 0
    s_nop 1
    s_cbranch_scc1 LA_H1
    s_cmp_lg_u32 s11, s8
    s_cbranch_scc1 LA_H9
LA_H1:
    s_mov_b32 s66, 0
    s_bitcmp1_b32 s12, s5
    s_cbranch_scc1 LA_H9
    s_bitset1_b32 s64, s5
    s_mov_b32 s15, 2
    s_cmp_eq_u32 s10, 0
    s_cbranch_scc1 LA_H9
    s_mov_b32 s9, 3
LA_H2:
    s_cmp_eq_u32 s13, -1
    s_cbranch_scc1 LA_H3
    s_cmp_eq_u32 s9, 0
    s_cbranch_scc1 LA_H9
    s_sub_u32 s9, s9, 1
    buffer_load_dword v23, v11, s[56:59], s14 offen sc1
    s_waitcnt vmcnt(0)
    v_readfirstlane_b32 s13, v23
    s_nop 4
    s_branch LA_H2
LA_H3:
    s_mov_b32 s15, 1
LA_H9:
    v_mov_b32 v20, s15
    ds_write_b32 v10, v20
    s_nop 1
LA_JOIN:
    s_cmp_eq_u32 s10, 0
    s_cbranch_scc1 LA_NOPRE
    s_and_b32 s6, s5, 1
    s_lshl_b32 s9, s4, 1
    s_add_u32 s6, s6, s9
    s_lshr_b32 s7, s5, 1
    s_add_u32 s40, s36, 2097152
    s_addc_u32 s41, s37, 0
    s_and_b32 s41, s41, 0xffff
    s_mov_b32 s42, 2097152
    s_mov_b32 s43, 0x20000
    s_mov_b32 s44, s24
    s_and_b32 s45, s25, 0xffff
    s_mov_b32 s46, 1835008
    s_mov_b32 s47, 0x20000
    s_lshl_b32 s13, s6, 3
    s_lshl_b32 s11, s62, 1
    s_add_u32 s13, s13, s11
    s_lshl_b32 s13, s13, 14
    s_lshl_b32 s11, s62, 11
    s_mul_i32 s12, s62, 28672
    s_lshl_b32 s9, s7, 8
    s_add_u32 s12, s12, s9
    v_lshlrev_b32 v14, 7, v1
    s_nop 2
LA_KSP:
    ds_read_b32 v20, v15 offset:16
    s_waitcnt lgkmcnt(0)
    v_readfirstlane_b32 s9, v20
    s_cmp_lt_u32 s9, 3
    s_nop 3
    s_cbranch_scc1 LA_KSP
    s_cmp_ge_u32 s5, 28
    s_cbranch_scc1 LA_NOPB
    s_add_u32 s15, s12, 0
    s_add_u32 m0, s11, 131072
    s_nop 0
    buffer_load_dwordx4 v6, s[44:47], s15 offen lds
    s_add_u32 s15, s12, 14336
    s_add_u32 m0, s11, 132096
    s_nop 0
    buffer_load_dwordx4 v7, s[44:47], s15 offen lds
    s_add_u32 s15, s12, 114688
    s_add_u32 m0, s11, 139264
    s_nop 0
    buffer_load_dwordx4 v6, s[44:47], s15 offen lds
    s_add_u32 s15, s12, 129024
    s_add_u32 m0, s11, 140288
    s_nop 0
    buffer_load_dwordx4 v7, s[44:47], s15 offen lds
    s_add_u32 s15, s12, 229376
    s_add_u32 m0, s11, 147456
    s_nop 0
    buffer_load_dwordx4 v6, s[44:47], s15 offen lds
    s_add_u32 s15, s12, 243712
    s_add_u32 m0, s11, 148480
    s_nop 0
    buffer_load_dwordx4 v7, s[44:47], s15 offen lds
LA_NOPB:
    s_cmp_lg_u32 s62, 2
    s_cbranch_scc1 LA_NT3
    s_add_u32 s48, s36, 14680064
    s_addc_u32 s49, s37, 0
    s_and_b32 s49, s49, 0xffff
    s_mov_b32 s50, 262144
    s_mov_b32 s51, 0x20000
    s_lshl_b32 s9, s4, 5
    s_add_u32 s9, s9, s5
    s_lshl_b32 s15, s9, 13
    buffer_load_dword v24, v14, s[40:43], s15 offen
    s_lshl_b32 s15, s9, 10
    s_mov_b64 exec, 0xff
    buffer_load_dword v25, v14, s[48:51], s15 offen
    s_mov_b64 exec, -1
LA_NT3:
    s_cmp_lg_u32 s62, 1
    s_cbranch_scc1 LA_NT2
    s_cmp_ge_u32 s2, 224
    s_cbranch_scc1 LA_NT2
    s_mov_b32 s52, s28
    s_and_b32 s53, s29, 0xffff
    s_mov_b32 s54, 1835008
    s_mov_b32 s55, 0x20000
    s_lshl_b32 s15, s2, 13
    v_lshlrev_b32 v14, 7, v1
    buffer_load_dword v23, v14, s[52:55], s15 offen
    s_nop 1
LA_NT2:
    s_cmp_ge_u32 s5, 28
    s_cbranch_scc1 LA_NOPRE
    v_subrev_u32 v21, 32, v15
    s_nop 2
LA_EW:
    ds_read_b32 v20, v21
    s_waitcnt lgkmcnt(0)
    v_readfirstlane_b32 s9, v20
    s_cmp_lt_u32 s9, 2
    s_nop 3
    s_cbranch_scc1 LA_EW
    s_mul_i32 s9, s62, 86016
    s_add_u32 s9, s9, s12
    s_lshl_b32 s39, s62, 14
    s_add_u32 s15, s9, 344064
    s_add_u32 m0, s39, 0
    s_nop 0
    buffer_load_dwordx4 v6, s[44:47], s15 offen lds
    s_add_u32 s15, s9, 358400
    s_add_u32 m0, s39, 1024
    s_nop 0
    buffer_load_dwordx4 v7, s[44:47], s15 offen lds
    s_add_u32 s15, s9, 372736
    s_add_u32 m0, s39, 2048
    s_nop 0
    buffer_load_dwordx4 v6, s[44:47], s15 offen lds
    s_add_u32 s15, s9, 387072
    s_add_u32 m0, s39, 3072
    s_nop 0
    buffer_load_dwordx4 v7, s[44:47], s15 offen lds
    s_add_u32 s15, s9, 401408
    s_add_u32 m0, s39, 4096
    s_nop 0
    buffer_load_dwordx4 v6, s[44:47], s15 offen lds
    s_add_u32 s15, s9, 415744
    s_add_u32 m0, s39, 5120
    s_nop 0
    buffer_load_dwordx4 v7, s[44:47], s15 offen lds
    s_add_u32 s15, s9, 430080
    s_add_u32 m0, s39, 6144
    s_nop 0
    buffer_load_dwordx4 v6, s[44:47], s15 offen lds
    s_add_u32 s15, s9, 444416
    s_add_u32 m0, s39, 7168
    s_nop 0
    buffer_load_dwordx4 v7, s[44:47], s15 offen lds
LA_NOPRE:
    s_waitcnt lgkmcnt(0)
    s_barrier
    ds_read_b32 v20, v10
    s_waitcnt lgkmcnt(0)
    v_readfirstlane_b32 s9, v20
    s_cmp_eq_u32 s9, 1
    s_nop 3
    s_cbranch_scc1 LA_FAST
    s_mov_b32 s10, 0
    s_branch L_DISP
LA_FAST:
    s_cmp_lt_u32 s5, 28
    s_cbranch_scc1 LB_MAIN
    s_barrier
    s_branch LC_ENTRY
LB_ENTRY:
    s_and_b32 s6, s5, 1
    s_lshl_b32 s9, s4, 1
    s_add_u32 s6, s6, s9
    s_lshr_b32 s7, s5, 1
    s_add_u32 s40, s36, 2097152
    s_addc_u32 s41, s37, 0
    s_and_b32 s41, s41, 0xffff
    s_mov_b32 s42, 2097152
    s_mov_b32 s43, 0x20000
    s_mov_b32 s44, s24
    s_and_b32 s45, s25, 0xffff
    s_mov_b32 s46, 1835008
    s_mov_b32 s47, 0x20000
    s_lshl_b32 s13, s6, 3
    s_lshl_b32 s11, s62, 1
    s_add_u32 s13, s13, s11
    s_lshl_b32 s13, s13, 14
    s_lshl_b32 s11, s62, 11
    s_mul_i32 s12, s62, 28672
    s_lshl_b32 s9, s7, 8
    s_add_u32 s12, s12, s9
    s_add_u32 s15, s12, 0
    s_add_u32 m0, s11, 131072
    s_nop 0
    buffer_load_dwordx4 v6, s[44:47], s15 offen lds
    s_add_u32 s15, s12, 14336
    s_add_u32 m0, s11, 132096
    s_nop 0
    buffer_load_dwordx4 v7, s[44:47], s15 offen lds
    s_add_u32 s15, s12, 114688
    s_add_u32 m0, s11, 139264
    s_nop 0
    buffer_load_dwordx4 v6, s[44:47], s15 offen lds
    s_add_u32 s15, s12, 129024
    s_add_u32 m0, s11, 140288
    s_nop 0
    buffer_load_dwordx4 v7, s[44:47], s15 offen lds
    s_add_u32 s15, s12, 229376
    s_add_u32 m0, s11, 147456
    s_nop 0
    buffer_load_dwordx4 v6, s[44:47], s15 offen lds
    s_add_u32 s15, s12, 243712
    s_add_u32 m0, s11, 148480
    s_nop 0
    buffer_load_dwordx4 v7, s[44:47], s15 offen lds
    s_mul_i32 s9, s62, 86016
    s_add_u32 s9, s9, s12
    s_lshl_b32 s39, s62, 14
    s_add_u32 s15, s9, 344064
    s_add_u32 m0, s39, 0
    s_nop 0
    buffer_load_dwordx4 v6, s[44:47], s15 offen lds
    s_add_u32 s15, s9, 358400
    s_add_u32 m0, s39, 1024
    s_nop 0
    buffer_load_dwordx4 v7, s[44:47], s15 offen lds
    s_add_u32 s15, s9, 372736
    s_add_u32 m0, s39, 2048
    s_nop 0
    buffer_load_dwordx4 v6, s[44:47], s15 offen lds
    s_add_u32 s15, s9, 387072
    s_add_u32 m0, s39, 3072
    s_nop 0
    buffer_load_dwordx4 v7, s[44:47], s15 offen lds
    s_add_u32 s15, s9, 401408
    s_add_u32 m0, s39, 4096
    s_nop 0
    buffer_load_dwordx4 v6, s[44:47], s15 offen lds
    s_add_u32 s15, s9, 415744
    s_add_u32 m0, s39, 5120
    s_nop 0
    buffer_load_dwordx4 v7, s[44:47], s15 offen lds
    s_add_u32 s15, s9, 430080
    s_add_u32 m0, s39, 6144
    s_nop 0
    buffer_load_dwordx4 v6, s[44:47], s15 offen lds
    s_add_u32 s15, s9, 444416
    s_add_u32 m0, s39, 7168
    s_nop 0
    buffer_load_dwordx4 v7, s[44:47], s15 offen lds
LB_MAIN:
    s_add_u32 s48, s36, 14680064
    s_addc_u32 s49, s37, 0
    s_and_b32 s49, s49, 0xffff
    s_mov_b32 s50, 262144
    s_mov_b32 s51, 0x20000
    v_lshlrev_b32 v12, 7, v2
    v_lshl_add_u32 v12, v3, 5, v12
    s_lshl_b32 s38, s6, 7
    s_lshl_b32 s9, s62, 5
    s_add_u32 s38, s38, s9
    s_lshl_b32 s38, s38, 7
    s_lshl_b32 s9, s62, 8
    s_add_u32 s9, s9, 155648
    v_lshl_add_u32 v13, v2, 3, s9
    s_lshl_b32 s14, s4, 12
    s_and_b32 s9, s5, 1
    s_lshl_b32 s9, s9, 9
    s_add_u32 s14, s14, s9
    s_cmp_eq_u32 s10, 0
    s_cbranch_scc1 LB_CN1
    v_mov_b32 v22, 163712
    s_nop 2
LB_CN0:
    ds_read_b32 v16, v22 offset:16
    s_waitcnt lgkmcnt(0)
    v_readfirstlane_b32 s9, v16
    s_cmp_lt_u32 s9, 8
    s_nop 3
    s_cbranch_scc1 LB_CN0
LB_CN1:
    buffer_load_dwordx2 v[16:17], v9, s[56:59], s14 offen sc1
    s_add_u32 s15, s12, 802816
    s_add_u32 m0, s11, 81920
    s_nop 0
    buffer_load_dwordx4 v6, s[44:47], s15 offen lds
    s_add_u32 s15, s12, 817152
    s_add_u32 m0, s11, 82944
    s_nop 0
    buffer_load_dwordx4 v7, s[44:47], s15 offen lds
    s_add_u32 s15, s12, 917504
    s_add_u32 m0, s11, 122880
    s_nop 0
    buffer_load_dwordx4 v6, s[44:47], s15 offen lds
    s_add_u32 s15, s12, 931840
    s_add_u32 m0, s11, 123904
    s_nop 0
    buffer_load_dwordx4 v7, s[44:47], s15 offen lds
    s_waitcnt vmcnt(4)
    v_and_b32 v22, v16, v17
    v_cmp_ne_u32 vcc, 0, v22
    s_cmp_eq_u64 vcc, -1
    s_nop 3
    s_cbranch_scc1 LB_POLLX
    s_mov_b32 s60, -1
    s_mov_b32 s61, -1
    s_mov_b64 exec, s[60:61]
    s_mov_b32 s9, 262144
LB_POLL:
    buffer_load_dwordx2 v[16:17], v9, s[56:59], s14 offen sc1
LB_POLLM:
    s_waitcnt vmcnt(0)
    v_and_b32 v22, v16, v17
    v_cmp_ne_u32 vcc, 0, v22
    s_cmp_eq_u64 vcc, s[60:61]
    s_nop 3
    s_cbranch_scc1 LB_POLLX
    s_sub_u32 s9, s9, 1
    s_cmp_lg_u32 s9, 0
    s_cbranch_scc1 LB_POLL
LB_POLLX:
    s_mov_b64 exec, -1
    s_add_u32 s15, s13, 0
    s_add_u32 m0, s11, 40960
    s_nop 0
    buffer_load_dwordx4 v4, s[40:43], s15 offen sc1 lds
    s_add_u32 s15, s13, 16384
    s_add_u32 m0, s11, 41984
    s_nop 0
    buffer_load_dwordx4 v4, s[40:43], s15 offen sc1 lds
    s_add_u32 s15, s13, 1024
    s_add_u32 m0, s11, 8192
    s_nop 0
    buffer_load_dwordx4 v4, s[40:43], s15 offen sc1 lds
    s_add_u32 s15, s13, 17408
    s_add_u32 m0, s11, 9216
    s_nop 0
    buffer_load_dwordx4 v4, s[40:43], s15 offen sc1 lds
    s_add_u32 s15, s13, 2048
    s_add_u32 m0, s11, 24576
    s_nop 0
    buffer_load_dwordx4 v4, s[40:43], s15 offen sc1 lds
    s_add_u32 s15, s13, 18432
    s_add_u32 m0, s11, 25600
    s_nop 0
    buffer_load_dwordx4 v4, s[40:43], s15 offen sc1 lds
    s_add_u32 s15, s13, 3072
    s_add_u32 m0, s11, 57344
    s_nop 0
    buffer_load_dwordx4 v4, s[40:43], s15 offen sc1 lds
    s_add_u32 s15, s13, 19456
    s_add_u32 m0, s11, 58368
    s_nop 0
    buffer_load_dwordx4 v4, s[40:43], s15 offen sc1 lds
    buffer_load_dwordx4 v[24:27], v12, s[48:51], s38 offen sc1
    buffer_load_dwordx4 v[28:31], v12, s[48:51], s38 offen offset:16 sc1
    buffer_load_dwordx4 v[32:35], v12, s[48:51], s38 offen offset:2048 sc1
    buffer_load_dwordx4 v[36:39], v12, s[48:51], s38 offen offset:2064 sc1
    s_waitcnt vmcnt(10)
    s_barrier
    s_add_u32 s15, s13, 4096
    s_add_u32 m0, s11, 90112
    s_nop 0
    buffer_load_dwordx4 v4, s[40:43], s15 offen sc1 lds
    s_add_u32 s15, s13, 20480
    s_add_u32 m0, s11, 91136
    s_nop 0
    buffer_load_dwordx4 v4, s[40:43], s15 offen sc1 lds
    s_add_u32 s15, s13, 5120
    s_add_u32 m0, s11, 65536
    s_nop 0
    buffer_load_dwordx4 v4, s[40:43], s15 offen sc1 lds
    s_add_u32 s15, s13, 21504
    s_add_u32 m0, s11, 66560
    s_nop 0
    buffer_load_dwordx4 v4, s[40:43], s15 offen sc1 lds
    s_waitcnt vmcnt(12)
    s_barrier
    s_add_u32 s15, s13, 6144
    s_add_u32 m0, s11, 40960
    s_nop 0
    buffer_load_dwordx4 v4, s[40:43], s15 offen sc1 lds
    s_add_u32 s15, s13, 22528
    s_add_u32 m0, s11, 41984
    s_nop 0
    buffer_load_dwordx4 v4, s[40:43], s15 offen sc1 lds
    s_waitcnt vmcnt(12)
    s_barrier
    s_add_u32 s15, s13, 7168
    s_add_u32 m0, s11, 8192
    s_nop 0
    buffer_load_dwordx4 v4, s[40:43], s15 offen sc1 lds
    s_add_u32 s15, s13, 23552
    s_add_u32 m0, s11, 9216
    s_nop 0
    buffer_load_dwordx4 v4, s[40:43], s15 offen sc1 lds
    s_add_u32 s15, s12, 1032192
    s_add_u32 m0, s11, 131072
    s_nop 0
    buffer_load_dwordx4 v6, s[44:47], s15 offen lds
    s_add_u32 s15, s12, 1046528
    s_add_u32 m0, s11, 132096
    s_nop 0
    buffer_load_dwordx4 v7, s[44:47], s15 offen lds
    s_waitcnt vmcnt(14)
    s_barrier
    s_add_u32 s15, s13, 8192
    s_add_u32 m0, s11, 24576
    s_nop 0
    buffer_load_dwordx4 v4, s[40:43], s15 offen sc1 lds
    s_add_u32 s15, s13, 24576
    s_add_u32 m0, s11, 25600
    s_nop 0
    buffer_load_dwordx4 v4, s[40:43], s15 offen sc1 lds
    s_add_u32 s15, s12, 1146880
    s_add_u32 m0, s11, 73728
    s_nop 0
    buffer_load_dwordx4 v6, s[44:47], s15 offen lds
    s_add_u32 s15, s12, 1161216
    s_add_u32 m0, s11, 74752
    s_nop 0
    buffer_load_dwordx4 v7, s[44:47], s15 offen lds
    s_waitcnt vmcnt(12)
    s_barrier
    s_add_u32 s15, s13, 9216
    s_add_u32 m0, s11, 57344
    s_nop 0
    buffer_load_dwordx4 v4, s[40:43], s15 offen sc1 lds
    v_add_f32 v24, v24, v26
    v_add_f32 v32, v32, v34
    v_add_f32 v25, v25, v27
    v_add_f32 v33, v33, v35
    v_add_f32 v24, v24, v28
    s_add_u32 s15, s13, 25600
    s_add_u32 m0, s11, 58368
    s_nop 0
    buffer_load_dwordx4 v4, s[40:43], s15 offen sc1 lds
    v_add_f32 v32, v32, v36
    v_add_f32 v25, v25, v29
    v_add_f32 v33, v33, v37
    v_add_f32 v24, v24, v30
    v_add_f32 v32, v32, v38
    s_add_u32 s15, s12, 1261568
    s_add_u32 m0, s11, 98304
    s_nop 0
    buffer_load_dwordx4 v6, s[44:47], s15 offen lds
    v_add_f32 v25, v25, v31
    v_add_f32 v33, v33, v39
    v_mov_b32 v26, v24
    v_mov_b32 v34, v32
    s_nop 0
    v_permlane16_swap_b32 v24, v26
    s_add_u32 s15, s12, 1275904
    s_add_u32 m0, s11, 99328
    s_nop 0
    buffer_load_dwordx4 v7, s[44:47], s15 offen lds
    v_permlane16_swap_b32 v32, v34
    v_add_f32 v24, v24, v26
    s_waitcnt vmcnt(14)
    s_barrier
    s_add_u32 s15, s13, 10240
    s_add_u32 m0, s11, 90112
    s_nop 0
    buffer_load_dwordx4 v4, s[40:43], s15 offen sc1 lds
    v_add_f32 v32, v32, v34
    v_mov_b32 v26, v24
    v_mov_b32 v34, v32
    s_nop 0
    v_permlane32_swap_b32 v24, v26
    v_permlane32_swap_b32 v32, v34
    s_add_u32 s15, s13, 26624
    s_add_u32 m0, s11, 91136
    s_nop 0
PGS6:
    s_cbranch_execz PGS7
    buffer_load_dwordx4 v4, s[40:43], s15 offen sc1 lds
    v_add_f32 v24, v24, v26
    v_add_f32 v32, v32, v34
    v_mov_b32 v27, v25
    v_mov_b32 v35, v33
    s_nop 0
    v_permlane16_swap_b32 v25, v27
    s_add_u32 s15, s12, 1376256
    s_add_u32 m0, s11, 16384
    s_nop 0
    buffer_load_dwordx4 v6, s[44:47], s15 offen lds
    v_permlane16_swap_b32 v33, v35
    v_add_f32 v25, v25, v27
    v_add_f32 v33, v33, v35
    v_mov_b32 v27, v25
    v_mov_b32 v35, v33
    s_add_u32 s15, s12, 1390592
    s_add_u32 m0, s11, 17408
    s_nop 0
    buffer_load_dwordx4 v7, s[44:47], s15 offen lds
    v_permlane32_swap_b32 v25, v27
    v_permlane32_swap_b32 v33, v35
    s_waitcnt vmcnt(16)
    s_barrier
    s_add_u32 s15, s13, 11264
    s_add_u32 m0, s11, 32768
    s_nop 0
    buffer_load_dwordx4 v4, s[40:43], s15 offen sc1 lds
    v_add_f32 v25, v25, v27
    v_add_f32 v33, v33, v35
    v_mul_f32 v26, 0x3b000000, v24
    v_mul_f32 v34, 0x3b000000, v32
    v_mul_f32 v27, 0x3b000000, v25
    s_add_u32 s15, s13, 27648
    s_add_u32 m0, s11, 33792
    s_nop 0
    buffer_load_dwordx4 v4, s[40:43], s15 offen sc1 lds
    v_mul_f32 v35, 0x3b000000, v33
    v_fma_f32 v27, -v26, v26, v27
    v_fma_f32 v35, -v34, v34, v35
    v_max_f32 v27, 0, v27
    v_max_f32 v35, 0, v35
    s_add_u32 s15, s12, 1490944
    s_add_u32 m0, s11, 65536
    s_nop 0
    buffer_load_dwordx4 v6, s[44:47], s15 offen lds
    v_cvt_pk_bf16_f32 v24, v26, v27
    v_cvt_pk_bf16_f32 v32, v34, v35
    v_and_b32 v25, 0xffff0000, v24
    v_and_b32 v33, 0xffff0000, v32
    v_lshlrev_b32 v24, 16, v24
    s_add_u32 s15, s12, 1505280
    s_add_u32 m0, s11, 66560
    s_nop 0
    buffer_load_dwordx4 v7, s[44:47], s15 offen lds
    v_lshlrev_b32 v32, 16, v32
    v_add_f32 v25, 0x3727c5ac, v25
    s_waitcnt vmcnt(18)
    s_barrier
    s_add_u32 s15, s13, 12288
    s_add_u32 m0, s11, 106496
    s_nop 0
    buffer_load_dwordx4 v4, s[40:43], s15 offen sc1 lds
    v_add_f32 v33, 0x3727c5ac, v33
    v_cvt_pk_bf16_f32 v25, v25, v25
    v_cvt_pk_bf16_f32 v33, v33, v33
    v_lshlrev_b32 v25, 16, v25
    v_lshlrev_b32 v33, 16, v33
    s_add_u32 s15, s13, 28672
    s_add_u32 m0, s11, 107520
    s_nop 0
    buffer_load_dwordx4 v4, s[40:43], s15 offen sc1 lds
    v_sqrt_f32 v25, v25
    v_sqrt_f32 v33, v33
    v_cvt_pk_bf16_f32 v25, v25, v25
    v_cvt_pk_bf16_f32 v33, v33, v33
    v_lshlrev_b32 v25, 16, v25
    s_add_u32 s15, s12, 1605632
    s_add_u32 m0, s11, 114688
    s_nop 0
    buffer_load_dwordx4 v6, s[44:47], s15 offen lds
    v_lshlrev_b32 v33, 16, v33
    v_rcp_f32 v28, v25
    v_rcp_f32 v36, v33
    v_sub_f32 v26, v26, v24
    v_sub_f32 v34, v34, v32
    s_add_u32 s15, s12, 1619968
    s_add_u32 m0, s11, 115712
    s_nop 0
    buffer_load_dwordx4 v7, s[44:47], s15 offen lds
    v_mul_f32 v26, v26, v28
    v_mul_f32 v34, v34, v36
    s_waitcnt vmcnt(18)
    s_barrier
    s_add_u32 s15, s13, 13312
    s_add_u32 m0, s11, 139264
    s_nop 0
    buffer_load_dwordx4 v4, s[40:43], s15 offen sc1 lds
    v_mul_f32 v27, v27, v28
    v_mul_f32 v35, v35, v36
    v_mul_f32 v27, v27, v28
    v_mul_f32 v35, v35, v36
    v_cvt_pk_bf16_f32 v29, v26, v27
    s_add_u32 s15, s13, 29696
    s_add_u32 m0, s11, 140288
    s_nop 0
    buffer_load_dwordx4 v4, s[40:43], s15 offen sc1 lds
    v_cvt_pk_bf16_f32 v37, v34, v35
    v_and_b32 v27, 0xffff0000, v29
    v_and_b32 v35, 0xffff0000, v37
    v_lshlrev_b32 v26, 16, v29
    v_lshlrev_b32 v34, 16, v37
    s_add_u32 s15, s12, 1720320
    s_add_u32 m0, s11, 147456
    s_nop 0
    buffer_load_dwordx4 v6, s[44:47], s15 offen lds
    v_add_f32 v27, 0x3727c5ac, v27
    v_add_f32 v35, 0x3727c5ac, v35
    v_cvt_pk_bf16_f32 v29, v27, v27
    v_cvt_pk_bf16_f32 v37, v35, v35
    v_lshlrev_b32 v27, 16, v29
    s_add_u32 s15, s12, 1734656
    s_add_u32 m0, s11, 148480
    s_nop 0
    buffer_load_dwordx4 v7, s[44:47], s15 offen lds
    v_lshlrev_b32 v35, 16, v37
    v_sqrt_f32 v27, v27
    s_waitcnt vmcnt(18)
    s_barrier
    s_mov_b32 s52, s28
    s_and_b32 s53, s29, 0xffff
    s_mov_b32 s54, 1835008
    s_mov_b32 s55, 0x20000
    s_mul_i32 s38, s62, 40960
    s_lshl_b32 s39, s62, 15
    s_lshr_b32 s9, s5, 2
    s_lshl_b32 s9, s9, 7
    s_add_u32 s39, s39, s9
    s_add_u32 s15, s13, 14336
    s_add_u32 m0, s11, 24576
    s_nop 0
    buffer_load_dwordx4 v4, s[40:43], s15 offen sc1 lds
    v_sqrt_f32 v35, v35
    v_cvt_pk_bf16_f32 v29, v27, v27
    v_cvt_pk_bf16_f32 v37, v35, v35
    v_lshlrev_b32 v27, 16, v29
    s_add_u32 s15, s13, 30720
    s_add_u32 m0, s11, 25600
    s_nop 0
    buffer_load_dwordx4 v4, s[40:43], s15 offen sc1 lds
    v_lshlrev_b32 v35, 16, v37
    v_fma_f32 v24, v26, v25, v24
    v_fma_f32 v32, v34, v33, v32
    v_rcp_f32 v27, v27
    s_add_u32 s15, s39, 0
    s_add_u32 m0, s38, 0
    s_nop 0
    buffer_load_dwordx4 v5, s[52:55], s15 offen lds
    v_rcp_f32 v35, v35
    v_mul_f32 v25, v28, v27
    v_mul_f32 v33, v36, v35
    ds_write_b64 v13, v[24:25]
    s_add_u32 s15, s39, 8192
    s_add_u32 m0, s38, 1024
    s_nop 0
    buffer_load_dwordx4 v5, s[52:55], s15 offen lds
    ds_write_b64 v13, v[32:33] offset:128
    s_waitcnt vmcnt(18)
    s_barrier
    s_add_u32 s15, s13, 15360
    s_add_u32 m0, s11, 57344
    s_nop 0
    buffer_load_dwordx4 v4, s[40:43], s15 offen sc1 lds
    s_add_u32 s15, s13, 31744
    s_add_u32 m0, s11, 58368
    s_nop 0
    buffer_load_dwordx4 v4, s[40:43], s15 offen sc1 lds
    s_add_u32 s15, s39, 16384
    s_add_u32 m0, s38, 2048
    s_nop 0
    buffer_load_dwordx4 v5, s[52:55], s15 offen lds
    s_add_u32 s15, s39, 24576
    s_add_u32 m0, s38, 3072
    s_nop 0
    buffer_load_dwordx4 v5, s[52:55], s15 offen lds
    s_waitcnt vmcnt(18)
    s_waitcnt lgkmcnt(0)
    s_barrier
    s_add_u32 s15, s39, 131072
    s_add_u32 m0, s38, 4096
    s_nop 0
    buffer_load_dwordx4 v5, s[52:55], s15 offen lds
    s_add_u32 s15, s39, 139264
    s_add_u32 m0, s38, 5120
    s_nop 0
    buffer_load_dwordx4 v5, s[52:55], s15 offen lds
    s_add_u32 s15, s39, 147456
    s_add_u32 m0, s38, 6144
    s_nop 0
    buffer_load_dwordx4 v5, s[52:55], s15 offen lds
    s_add_u32 s15, s39, 155648
    s_add_u32 m0, s38, 7168
    s_nop 0
    buffer_load_dwordx4 v5, s[52:55], s15 offen lds
    s_waitcnt vmcnt(18)
    s_barrier
    s_add_u32 s15, s39, 262144
    s_add_u32 m0, s38, 8192
    s_nop 0
    buffer_load_dwordx4 v5, s[52:55], s15 offen lds
    s_add_u32 s15, s39, 270336
    s_add_u32 m0, s38, 9216
    s_nop 0
    buffer_load_dwordx4 v5, s[52:55], s15 offen lds
    s_add_u32 s15, s39, 278528
    s_add_u32 m0, s38, 10240
    s_nop 0
    buffer_load_dwordx4 v5, s[52:55], s15 offen lds
    s_add_u32 s15, s39, 286720
    s_add_u32 m0, s38, 11264
    s_nop 0
    buffer_load_dwordx4 v5, s[52:55], s15 offen lds
    s_waitcnt vmcnt(18)
    s_barrier
    s_add_u32 s15, s39, 393216
    s_add_u32 m0, s38, 12288
    s_nop 0
    buffer_load_dwordx4 v5, s[52:55], s15 offen lds
    s_add_u32 s15, s39, 401408
    s_add_u32 m0, s38, 13312
    s_nop 0
    buffer_load_dwordx4 v5, s[52:55], s15 offen lds
    s_add_u32 s15, s39, 409600
    s_add_u32 m0, s38, 14336
    s_nop 0
    buffer_load_dwordx4 v5, s[52:55], s15 offen lds
    s_add_u32 s15, s39, 417792
    s_add_u32 m0, s38, 15360
    s_nop 0
    buffer_load_dwordx4 v5, s[52:55], s15 offen lds
    s_waitcnt vmcnt(18)
    s_barrier
    s_waitcnt vmcnt(14)
    s_barrier
    s_waitcnt vmcnt(0)
    s_barrier
    s_add_u32 s15, s39, 524288
    s_add_u32 m0, s38, 16384
    s_nop 0
    buffer_load_dwordx4 v5, s[52:55], s15 offen lds
    s_add_u32 s15, s39, 532480
    s_add_u32 m0, s38, 17408
    s_nop 0
    buffer_load_dwordx4 v5, s[52:55], s15 offen lds
    s_add_u32 s15, s39, 540672
    s_add_u32 m0, s38, 18432
    s_nop 0
    buffer_load_dwordx4 v5, s[52:55], s15 offen lds
    s_add_u32 s15, s39, 548864
    s_add_u32 m0, s38, 19456
    s_nop 0
    buffer_load_dwordx4 v5, s[52:55], s15 offen lds
    s_add_u32 s15, s39, 655360
    s_add_u32 m0, s38, 20480
    s_nop 0
    buffer_load_dwordx4 v5, s[52:55], s15 offen lds
    s_add_u32 s15, s39, 663552
    s_add_u32 m0, s38, 21504
    s_nop 0
    buffer_load_dwordx4 v5, s[52:55], s15 offen lds
    s_add_u32 s15, s39, 671744
    s_add_u32 m0, s38, 22528
    s_nop 0
    buffer_load_dwordx4 v5, s[52:55], s15 offen lds
    s_add_u32 s15, s39, 679936
    s_add_u32 m0, s38, 23552
    s_nop 0
    buffer_load_dwordx4 v5, s[52:55], s15 offen lds
    s_add_u32 s15, s39, 786432
    s_add_u32 m0, s38, 24576
    s_nop 0
    buffer_load_dwordx4 v5, s[52:55], s15 offen lds
    s_add_u32 s15, s39, 794624
    s_add_u32 m0, s38, 25600
    s_nop 0
    buffer_load_dwordx4 v5, s[52:55], s15 offen lds
    s_add_u32 s15, s39, 802816
    s_add_u32 m0, s38, 26624
    s_nop 0
    buffer_load_dwordx4 v5, s[52:55], s15 offen lds
    s_add_u32 s15, s39, 811008
    s_add_u32 m0, s38, 27648
    s_nop 0
    buffer_load_dwordx4 v5, s[52:55], s15 offen lds
    s_add_u32 s15, s39, 917504
    s_add_u32 m0, s38, 28672
    s_nop 0
    buffer_load_dwordx4 v5, s[52:55], s15 offen lds
    s_add_u32 s15, s39, 925696
    s_add_u32 m0, s38, 29696
    s_nop 0
    buffer_load_dwordx4 v5, s[52:55], s15 offen lds
    s_add_u32 s15, s39, 933888
    s_add_u32 m0, s38, 30720
    s_nop 0
    buffer_load_dwordx4 v5, s[52:55], s15 offen lds
    s_add_u32 s15, s39, 942080
    s_add_u32 m0, s38, 31744
    s_nop 0
    buffer_load_dwordx4 v5, s[52:55], s15 offen lds
    s_barrier
    s_cmp_lg_u32 s10, 0
    s_cbranch_scc1 LC_J
    s_branch L_DISP
LC_ENTRY:
    s_mov_b32 s52, s28
    s_and_b32 s53, s29, 0xffff
    s_mov_b32 s54, 1835008
    s_mov_b32 s55, 0x20000
    s_mul_i32 s38, s62, 40960
    s_lshl_b32 s39, s62, 15
    s_lshr_b32 s9, s5, 2
    s_lshl_b32 s9, s9, 7
    s_add_u32 s39, s39, s9
    s_add_u32 s15, s39, 0
    s_add_u32 m0, s38, 0
    s_nop 0
    buffer_load_dwordx4 v5, s[52:55], s15 offen lds
    s_add_u32 s15, s39, 8192
    s_add_u32 m0, s38, 1024
    s_nop 0
    buffer_load_dwordx4 v5, s[52:55], s15 offen lds
    s_add_u32 s15, s39, 16384
    s_add_u32 m0, s38, 2048
    s_nop 0
    buffer_load_dwordx4 v5, s[52:55], s15 offen lds
    s_add_u32 s15, s39, 24576
    s_add_u32 m0, s38, 3072
    s_nop 0
    buffer_load_dwordx4 v5, s[52:55], s15 offen lds
    s_add_u32 s15, s39, 131072
    s_add_u32 m0, s38, 4096
    s_nop 0
    buffer_load_dwordx4 v5, s[52:55], s15 offen lds
    s_add_u32 s15, s39, 139264
    s_add_u32 m0, s38, 5120
    s_nop 0
    buffer_load_dwordx4 v5, s[52:55], s15 offen lds
    s_add_u32 s15, s39, 147456
    s_add_u32 m0, s38, 6144
    s_nop 0
    buffer_load_dwordx4 v5, s[52:55], s15 offen lds
    s_add_u32 s15, s39, 155648
    s_add_u32 m0, s38, 7168
    s_nop 0
    buffer_load_dwordx4 v5, s[52:55], s15 offen lds
    s_add_u32 s15, s39, 262144
    s_add_u32 m0, s38, 8192
    s_nop 0
    buffer_load_dwordx4 v5, s[52:55], s15 offen lds
    s_add_u32 s15, s39, 270336
    s_add_u32 m0, s38, 9216
    s_nop 0
    buffer_load_dwordx4 v5, s[52:55], s15 offen lds
    s_add_u32 s15, s39, 278528
    s_add_u32 m0, s38, 10240
    s_nop 0
    buffer_load_dwordx4 v5, s[52:55], s15 offen lds
    s_add_u32 s15, s39, 286720
    s_add_u32 m0, s38, 11264
    s_nop 0
    buffer_load_dwordx4 v5, s[52:55], s15 offen lds
    s_add_u32 s15, s39, 393216
    s_add_u32 m0, s38, 12288
    s_nop 0
    buffer_load_dwordx4 v5, s[52:55], s15 offen lds
    s_add_u32 s15, s39, 401408
    s_add_u32 m0, s38, 13312
    s_nop 0
    buffer_load_dwordx4 v5, s[52:55], s15 offen lds
    s_add_u32 s15, s39, 409600
    s_add_u32 m0, s38, 14336
    s_nop 0
    buffer_load_dwordx4 v5, s[52:55], s15 offen lds
    s_add_u32 s15, s39, 417792
    s_add_u32 m0, s38, 15360
    s_nop 0
    buffer_load_dwordx4 v5, s[52:55], s15 offen lds
    s_add_u32 s15, s39, 524288
    s_add_u32 m0, s38, 16384
    s_nop 0
    buffer_load_dwordx4 v5, s[52:55], s15 offen lds
    s_add_u32 s15, s39, 532480
    s_add_u32 m0, s38, 17408
    s_nop 0
    buffer_load_dwordx4 v5, s[52:55], s15 offen lds
    s_add_u32 s15, s39, 540672
    s_add_u32 m0, s38, 18432
    s_nop 0
    buffer_load_dwordx4 v5, s[52:55], s15 offen lds
    s_add_u32 s15, s39, 548864
    s_add_u32 m0, s38, 19456
    s_nop 0
    buffer_load_dwordx4 v5, s[52:55], s15 offen lds
    s_add_u32 s15, s39, 655360
    s_add_u32 m0, s38, 20480
    s_nop 0
    buffer_load_dwordx4 v5, s[52:55], s15 offen lds
    s_add_u32 s15, s39, 663552
    s_add_u32 m0, s38, 21504
    s_nop 0
    buffer_load_dwordx4 v5, s[52:55], s15 offen lds
    s_add_u32 s15, s39, 671744
    s_add_u32 m0, s38, 22528
    s_nop 0
    buffer_load_dwordx4 v5, s[52:55], s15 offen lds
    s_add_u32 s15, s39, 679936
    s_add_u32 m0, s38, 23552
    s_nop 0
    buffer_load_dwordx4 v5, s[52:55], s15 offen lds
    s_add_u32 s15, s39, 786432
    s_add_u32 m0, s38, 24576
    s_nop 0
    buffer_load_dwordx4 v5, s[52:55], s15 offen lds
    s_add_u32 s15, s39, 794624
    s_add_u32 m0, s38, 25600
    s_nop 0
    buffer_load_dwordx4 v5, s[52:55], s15 offen lds
    s_add_u32 s15, s39, 802816
    s_add_u32 m0, s38, 26624
    s_nop 0
    buffer_load_dwordx4 v5, s[52:55], s15 offen lds
    s_add_u32 s15, s39, 811008
    s_add_u32 m0, s38, 27648
    s_nop 0
    buffer_load_dwordx4 v5, s[52:55], s15 offen lds
    s_add_u32 s15, s39, 917504
    s_add_u32 m0, s38, 28672
    s_nop 0
    buffer_load_dwordx4 v5, s[52:55], s15 offen lds
    s_add_u32 s15, s39, 925696
    s_add_u32 m0, s38, 29696
    s_nop 0
    buffer_load_dwordx4 v5, s[52:55], s15 offen lds
    s_add_u32 s15, s39, 933888
    s_add_u32 m0, s38, 30720
    s_nop 0
    buffer_load_dwordx4 v5, s[52:55], s15 offen lds
    s_add_u32 s15, s39, 942080
    s_add_u32 m0, s38, 31744
    s_nop 0
    buffer_load_dwordx4 v5, s[52:55], s15 offen lds
    s_waitcnt vmcnt(16)
    s_barrier
    s_barrier
LC_J:
    s_add_u32 s15, s39, 1048576
    s_add_u32 m0, s38, 0
    s_nop 0
    buffer_load_dwordx4 v5, s[52:55], s15 offen lds
    s_add_u32 s15, s39, 1056768
    s_add_u32 m0, s38, 1024
    s_nop 0
    buffer_load_dwordx4 v5, s[52:55], s15 offen lds
    s_add_u32 s15, s39, 1064960
    s_add_u32 m0, s38, 2048
    s_nop 0
    buffer_load_dwordx4 v5, s[52:55], s15 offen lds
    s_add_u32 s15, s39, 1073152
    s_add_u32 m0, s38, 3072
    s_nop 0
    buffer_load_dwordx4 v5, s[52:55], s15 offen lds
    s_add_u32 s15, s39, 1179648
    s_add_u32 m0, s38, 4096
    s_nop 0
    buffer_load_dwordx4 v5, s[52:55], s15 offen lds
    s_add_u32 s15, s39, 1187840
    s_add_u32 m0, s38, 5120
    s_nop 0
    buffer_load_dwordx4 v5, s[52:55], s15 offen lds
    s_add_u32 s15, s39, 1196032
    s_add_u32 m0, s38, 6144
    s_nop 0
    buffer_load_dwordx4 v5, s[52:55], s15 offen lds
    s_add_u32 s15, s39, 1204224
    s_add_u32 m0, s38, 7168
    s_nop 0
    buffer_load_dwordx4 v5, s[52:55], s15 offen lds
    s_add_u32 s15, s39, 1572864
    s_add_u32 m0, s38, 32768
    s_nop 0
    buffer_load_dwordx4 v5, s[52:55], s15 offen lds
    s_add_u32 s15, s39, 1581056
    s_add_u32 m0, s38, 33792
    s_nop 0
    buffer_load_dwordx4 v5, s[52:55], s15 offen lds
    s_add_u32 s15, s39, 1589248
    s_add_u32 m0, s38, 34816
    s_nop 0
    buffer_load_dwordx4 v5, s[52:55], s15 offen lds
    s_add_u32 s15, s39, 1597440
    s_add_u32 m0, s38, 35840
    s_nop 0
    buffer_load_dwordx4 v5, s[52:55], s15 offen lds
    s_add_u32 s15, s39, 1703936
    s_add_u32 m0, s38, 36864
    s_nop 0
    buffer_load_dwordx4 v5, s[52:55], s15 offen lds
    s_add_u32 s15, s39, 1712128
    s_add_u32 m0, s38, 37888
    s_nop 0
    buffer_load_dwordx4 v5, s[52:55], s15 offen lds
    s_add_u32 s15, s39, 1720320
    s_add_u32 m0, s38, 38912
    s_nop 0
    buffer_load_dwordx4 v5, s[52:55], s15 offen lds
    s_add_u32 s15, s39, 1728512
    s_add_u32 m0, s38, 39936
    s_nop 0
    buffer_load_dwordx4 v5, s[52:55], s15 offen lds
    s_and_b32 s6, s5, 3
    s_lshl_b32 s9, s4, 2
    s_add_u32 s6, s6, s9
    s_lshr_b32 s7, s5, 2
    s_add_u32 s40, s36, 4194304
    s_addc_u32 s41, s37, 0
    s_and_b32 s41, s41, 0xffff
    s_mov_b32 s42, 7340032
    s_mov_b32 s43, 0x20000
    s_mul_i32 s13, s6, 224
    s_add_u32 s13, s13, s62
    s_lshl_b32 s13, s13, 10
    s_lshl_b32 s14, s4, 12
    s_bfe_u32 s9, s5, 0x10001
    s_lshl_b32 s9, s9, 9
    s_add_u32 s14, s14, s9
    s_add_u32 s14, s14, 1024
    s_waitcnt vmcnt(16)
    s_barrier
    s_add_u32 s15, s39, 1310720
    s_add_u32 m0, s38, 8192
    s_nop 0
    buffer_load_dwordx4 v5, s[52:55], s15 offen lds
    s_add_u32 s15, s39, 1318912
    s_add_u32 m0, s38, 9216
    s_nop 0
    buffer_load_dwordx4 v5, s[52:55], s15 offen lds
    s_add_u32 s15, s39, 1327104
    s_add_u32 m0, s38, 10240
    s_nop 0
    buffer_load_dwordx4 v5, s[52:55], s15 offen lds
    s_add_u32 s15, s39, 1335296
    s_add_u32 m0, s38, 11264
    s_nop 0
    buffer_load_dwordx4 v5, s[52:55], s15 offen lds
    s_add_u32 s15, s39, 1441792
    s_add_u32 m0, s38, 12288
    s_nop 0
    buffer_load_dwordx4 v5, s[52:55], s15 offen lds
    s_add_u32 s15, s39, 1449984
    s_add_u32 m0, s38, 13312
    s_nop 0
    buffer_load_dwordx4 v5, s[52:55], s15 offen lds
    s_add_u32 s15, s39, 1458176
    s_add_u32 m0, s38, 14336
    s_nop 0
    buffer_load_dwordx4 v5, s[52:55], s15 offen lds
    s_add_u32 s15, s39, 1466368
    s_add_u32 m0, s38, 15360
    s_nop 0
    buffer_load_dwordx4 v5, s[52:55], s15 offen lds
    s_mov_b32 s60, -1
    s_mov_b32 s61, 16777215
    s_mov_b64 exec, s[60:61]
    s_mov_b32 s9, 262144
    buffer_load_dwordx2 v[16:17], v9, s[56:59], s14 offen sc1
    s_barrier
    s_branch LC_POLLM
LC_POLL:
    buffer_load_dwordx2 v[16:17], v9, s[56:59], s14 offen sc1
LC_POLLM:
    s_waitcnt vmcnt(0)
    v_and_b32 v22, v16, v17
    v_cmp_ne_u32 vcc, 0, v22
    s_cmp_eq_u64 vcc, s[60:61]
    s_nop 3
    s_cbranch_scc1 LC_POLLX
    s_sub_u32 s9, s9, 1
    s_cmp_lg_u32 s9, 0
    s_cbranch_scc1 LC_POLL
LC_POLLX:
    s_mov_b64 exec, -1
    s_add_u32 s15, s13, 0
    s_add_u32 m0, s38, 16384
    s_nop 0
    buffer_load_dwordx4 v4, s[40:43], s15 offen sc1 lds
    s_add_u32 s15, s13, 57344
    s_add_u32 m0, s38, 17408
    s_nop 0
    buffer_load_dwordx4 v4, s[40:43], s15 offen sc1 lds
    s_add_u32 s15, s13, 114688
    s_add_u32 m0, s38, 18432
    s_nop 0
    buffer_load_dwordx4 v4, s[40:43], s15 offen sc1 lds
    s_add_u32 s15, s13, 172032
    s_add_u32 m0, s38, 19456
    s_nop 0
    buffer_load_dwordx4 v4, s[40:43], s15 offen sc1 lds
    s_add_u32 s15, s13, 4096
    s_add_u32 m0, s38, 20480
    s_nop 0
    buffer_load_dwordx4 v4, s[40:43], s15 offen sc1 lds
    s_add_u32 s15, s13, 61440
    s_add_u32 m0, s38, 21504
    s_nop 0
    buffer_load_dwordx4 v4, s[40:43], s15 offen sc1 lds
    s_add_u32 s15, s13, 118784
    s_add_u32 m0, s38, 22528
    s_nop 0
    buffer_load_dwordx4 v4, s[40:43], s15 offen sc1 lds
    s_add_u32 s15, s13, 176128
    s_add_u32 m0, s38, 23552
    s_nop 0
    buffer_load_dwordx4 v4, s[40:43], s15 offen sc1 lds
    s_add_u32 s15, s13, 8192
    s_add_u32 m0, s38, 24576
    s_nop 0
    buffer_load_dwordx4 v4, s[40:43], s15 offen sc1 lds
    s_add_u32 s15, s13, 65536
    s_add_u32 m0, s38, 25600
    s_nop 0
    buffer_load_dwordx4 v4, s[40:43], s15 offen sc1 lds
    s_add_u32 s15, s13, 122880
    s_add_u32 m0, s38, 26624
PGS7:
    s_cbranch_execz CH_K2P_RET
    s_nop 0
    buffer_load_dwordx4 v4, s[40:43], s15 offen sc1 lds
    s_add_u32 s15, s13, 180224
    s_add_u32 m0, s38, 27648
    s_nop 0
    buffer_load_dwordx4 v4, s[40:43], s15 offen sc1 lds
    s_add_u32 s15, s13, 12288
    s_add_u32 m0, s38, 28672
    s_nop 0
    buffer_load_dwordx4 v4, s[40:43], s15 offen sc1 lds
    s_add_u32 s15, s13, 69632
    s_add_u32 m0, s38, 29696
    s_nop 0
    buffer_load_dwordx4 v4, s[40:43], s15 offen sc1 lds
    s_add_u32 s15, s13, 126976
    s_add_u32 m0, s38, 30720
    s_nop 0
    buffer_load_dwordx4 v4, s[40:43], s15 offen sc1 lds
    s_add_u32 s15, s13, 184320
    s_add_u32 m0, s38, 31744
    s_nop 0
    buffer_load_dwordx4 v4, s[40:43], s15 offen sc1 lds
    v_lshlrev_b32 v12, 12, v1
    v_mov_b32 v14, 28672
    s_waitcnt vmcnt(12)
    s_barrier
    s_waitcnt vmcnt(8)
    s_barrier
    s_add_u32 s15, s13, 16384
    s_add_u32 m0, s38, 16384
    s_nop 0
    buffer_load_dwordx4 v4, s[40:43], s15 offen sc1 lds
    s_add_u32 s15, s13, 73728
    s_add_u32 m0, s38, 17408
    s_nop 0
    buffer_load_dwordx4 v4, s[40:43], s15 offen sc1 lds
    s_add_u32 s15, s13, 131072
    s_add_u32 m0, s38, 18432
    s_nop 0
    buffer_load_dwordx4 v4, s[40:43], s15 offen sc1 lds
    s_add_u32 s15, s13, 188416
    s_add_u32 m0, s38, 19456
    s_nop 0
    buffer_load_dwordx4 v4, s[40:43], s15 offen sc1 lds
    s_waitcnt vmcnt(8)
    s_barrier
    s_add_u32 s15, s13, 20480
    s_add_u32 m0, s38, 20480
    s_nop 0
    buffer_load_dwordx4 v4, s[40:43], s15 offen sc1 lds
    s_add_u32 s15, s13, 77824
    s_add_u32 m0, s38, 21504
    s_nop 0
    buffer_load_dwordx4 v4, s[40:43], s15 offen sc1 lds
    s_add_u32 s15, s13, 135168
    s_add_u32 m0, s38, 22528
    s_nop 0
    buffer_load_dwordx4 v4, s[40:43], s15 offen sc1 lds
    s_add_u32 s15, s13, 192512
    s_add_u32 m0, s38, 23552
    s_nop 0
    buffer_load_dwordx4 v4, s[40:43], s15 offen sc1 lds
    s_waitcnt vmcnt(8)
    s_barrier
    s_add_u32 s15, s13, 24576
    s_add_u32 m0, s38, 24576
    s_nop 0
    buffer_load_dwordx4 v4, s[40:43], s15 offen sc1 lds
    s_add_u32 s15, s13, 81920
    s_add_u32 m0, s38, 25600
    s_nop 0
    buffer_load_dwordx4 v4, s[40:43], s15 offen sc1 lds
    s_add_u32 s15, s13, 139264
    s_add_u32 m0, s38, 26624
    s_nop 0
    buffer_load_dwordx4 v4, s[40:43], s15 offen sc1 lds
    s_add_u32 s15, s13, 196608
    s_add_u32 m0, s38, 27648
    s_nop 0
    buffer_load_dwordx4 v4, s[40:43], s15 offen sc1 lds
    s_waitcnt vmcnt(8)
    s_barrier
    s_add_u32 s15, s13, 28672
    s_add_u32 m0, s38, 28672
    s_nop 0
    buffer_load_dwordx4 v4, s[40:43], s15 offen sc1 lds
    s_add_u32 s15, s13, 86016
    s_add_u32 m0, s38, 29696
    s_nop 0
    buffer_load_dwordx4 v4, s[40:43], s15 offen sc1 lds
    s_add_u32 s15, s13, 143360
    s_add_u32 m0, s38, 30720
    s_nop 0
    buffer_load_dwordx4 v4, s[40:43], s15 offen sc1 lds
    s_add_u32 s15, s13, 200704
    s_add_u32 m0, s38, 31744
    s_nop 0
    buffer_load_dwordx4 v4, s[40:43], s15 offen sc1 lds
    s_waitcnt vmcnt(8)
    s_barrier
    s_add_u32 s15, s13, 32768
    s_add_u32 m0, s38, 16384
    s_nop 0
    buffer_load_dwordx4 v4, s[40:43], s15 offen sc1 lds
    s_add_u32 s15, s13, 90112
    s_add_u32 m0, s38, 17408
    s_nop 0
    buffer_load_dwordx4 v4, s[40:43], s15 offen sc1 lds
    s_add_u32 s15, s13, 147456
    s_add_u32 m0, s38, 18432
    s_nop 0
    buffer_load_dwordx4 v4, s[40:43], s15 offen sc1 lds
    s_add_u32 s15, s13, 204800
    s_add_u32 m0, s38, 19456
    s_nop 0
    buffer_load_dwordx4 v4, s[40:43], s15 offen sc1 lds
    s_waitcnt vmcnt(8)
    s_barrier
    s_add_u32 s15, s13, 36864
    s_add_u32 m0, s38, 20480
    s_nop 0
    buffer_load_dwordx4 v4, s[40:43], s15 offen sc1 lds
    s_add_u32 s15, s13, 94208
    s_add_u32 m0, s38, 21504
    s_nop 0
    buffer_load_dwordx4 v4, s[40:43], s15 offen sc1 lds
    s_add_u32 s15, s13, 151552
    s_add_u32 m0, s38, 22528
    s_nop 0
    buffer_load_dwordx4 v4, s[40:43], s15 offen sc1 lds
    s_add_u32 s15, s13, 208896
    s_add_u32 m0, s38, 23552
    s_nop 0
    buffer_load_dwordx4 v4, s[40:43], s15 offen sc1 lds
    s_waitcnt vmcnt(8)
    s_barrier
    s_add_u32 s15, s13, 40960
    s_add_u32 m0, s38, 24576
    s_nop 0
    buffer_load_dwordx4 v4, s[40:43], s15 offen sc1 lds
    s_add_u32 s15, s13, 98304
    s_add_u32 m0, s38, 25600
    s_nop 0
    buffer_load_dwordx4 v4, s[40:43], s15 offen sc1 lds
    s_add_u32 s15, s13, 155648
    s_add_u32 m0, s38, 26624
    s_nop 0
    buffer_load_dwordx4 v4, s[40:43], s15 offen sc1 lds
    s_add_u32 s15, s13, 212992
    s_add_u32 m0, s38, 27648
    s_nop 0
    buffer_load_dwordx4 v4, s[40:43], s15 offen sc1 lds
    s_waitcnt vmcnt(8)
    s_barrier
    s_add_u32 s15, s13, 45056
    s_add_u32 m0, s38, 28672
    s_nop 0
    buffer_load_dwordx4 v4, s[40:43], s15 offen sc1 lds
    s_add_u32 s15, s13, 102400
    s_add_u32 m0, s38, 29696
    s_nop 0
    buffer_load_dwordx4 v4, s[40:43], s15 offen sc1 lds
    s_add_u32 s15, s13, 159744
    s_add_u32 m0, s38, 30720
    s_nop 0
    buffer_load_dwordx4 v4, s[40:43], s15 offen sc1 lds
    s_add_u32 s15, s13, 217088
    s_add_u32 m0, s38, 31744
    s_nop 0
    buffer_load_dwordx4 v4, s[40:43], s15 offen sc1 lds
    s_waitcnt vmcnt(8)
    s_barrier
    s_add_u32 s15, s13, 49152
    s_add_u32 m0, s38, 16384
    s_nop 0
    buffer_load_dwordx4 v4, s[40:43], s15 offen sc1 lds
    s_add_u32 s15, s13, 106496
    s_add_u32 m0, s38, 17408
    s_nop 0
    buffer_load_dwordx4 v4, s[40:43], s15 offen sc1 lds
    s_add_u32 s15, s13, 163840
    s_add_u32 m0, s38, 18432
    s_nop 0
    buffer_load_dwordx4 v4, s[40:43], s15 offen sc1 lds
    s_add_u32 s15, s13, 221184
    s_add_u32 m0, s38, 19456
    s_nop 0
    buffer_load_dwordx4 v4, s[40:43], s15 offen sc1 lds
    s_mov_b64 exec, 0xff
    s_mov_b32 s9, 2048
    buffer_load_dword v20, v12, s[56:59], s9 offen sc1
    s_mov_b64 exec, -1
    s_waitcnt vmcnt(9)
    s_barrier
    s_add_u32 s15, s13, 53248
    s_add_u32 m0, s38, 20480
    s_nop 0
    buffer_load_dwordx4 v4, s[40:43], s15 offen sc1 lds
    s_add_u32 s15, s13, 110592
    s_add_u32 m0, s38, 21504
    s_nop 0
    buffer_load_dwordx4 v4, s[40:43], s15 offen sc1 lds
    s_add_u32 s15, s13, 167936
    s_add_u32 m0, s38, 22528
    s_nop 0
    buffer_load_dwordx4 v4, s[40:43], s15 offen sc1 lds
    s_add_u32 s15, s13, 225280
    s_add_u32 m0, s38, 23552
    s_nop 0
    buffer_load_dwordx4 v4, s[40:43], s15 offen sc1 lds
    s_waitcnt vmcnt(9)
    s_barrier
    s_waitcnt vmcnt(5)
    s_barrier
    s_waitcnt vmcnt(0)
    s_barrier
    s_waitcnt vmcnt(0)
    s_mov_b64 exec, 0xff
    v_cmp_eq_u32 vcc, 0, v20
    v_cmp_eq_u32 s[60:61], s8, v20
    s_mov_b64 exec, -1
    s_or_b32 s9, vcc_lo, s60
    s_bitset0_b32 s9, s4
    s_andn2_b32 s9, s9, s65
    s_cmp_eq_u32 s9, 0
    s_cselect_b32 s9, s10, 0
    v_mov_b32 v20, s9
    s_cmp_lg_u32 s62, 0
    s_nop 1
    s_cbranch_scc1 LC_ND
    ds_write_b32 v14, v20
    s_cmp_eq_u32 s10, 0
    s_cbranch_scc1 LC_ND
    s_mov_b32 s66, 3
LC_ND:
    s_waitcnt lgkmcnt(0)
    s_barrier
    ds_read_b32 v20, v14
    s_waitcnt lgkmcnt(0)
    v_readfirstlane_b32 s9, v20
    s_cmp_eq_u32 s9, 0
    s_nop 3
    s_cbranch_scc1 L_DISP0
    s_endpgm
L_DISP0:
    s_mov_b32 s10, 0
L_DISP:
    s_waitcnt vmcnt(0)
    s_cmp_lg_u32 s62, 0
    s_cbranch_scc1 H_BAR
H_S0:
    s_cmp_lg_u32 s66, 0
    s_cbranch_scc1 H_S1
    s_lshl_b32 s9, s4, 2
    s_add_u32 s14, s69, s9
    buffer_load_dword v23, v11, s[56:59], s14 offen sc1
    s_waitcnt vmcnt(0)
    v_readfirstlane_b32 s13, v23
    s_mov_b32 s15, 0
    s_ff0_i32_b32 s5, s13
    s_cmp_lg_u32 s13, -1
    s_nop 1
    s_cbranch_scc1 H_WR
    s_mov_b32 s66, 1
    s_and_b32 s67, s64, 0x0fffffff
H_S1:
    s_cmp_lg_u32 s66, 1
    s_cbranch_scc1 H_S2
    s_mov_b32 s15, 1
    s_cmp_lg_u32 s67, 0
    s_cbranch_scc1 H_TAKE
    s_mov_b32 s66, 2
    s_mov_b32 s67, s64
H_S2:
    s_cmp_lg_u32 s66, 2
    s_cbranch_scc1 H_S3
    s_mov_b32 s15, 2
    s_cmp_lg_u32 s67, 0
    s_cbranch_scc1 H_TAKE
H_S3:
    s_bitset1_b32 s65, s4
    v_lshlrev_b32 v12, 12, v1
    s_mov_b64 exec, 0xff
    s_mov_b32 s9, 2048
    buffer_load_dword v20, v12, s[56:59], s9 offen sc1
    s_waitcnt vmcnt(0)
    v_cmp_eq_u32 vcc, 0, v20
    v_cmp_eq_u32 s[60:61], s8, v20
    s_mov_b64 exec, -1
    s_or_b32 s9, vcc_lo, s60
    s_andn2_b32 s9, s9, s65
    s_mov_b32 s15, 3
    s_mov_b32 s5, 0
    s_cmp_eq_u32 s9, 0
    s_cbranch_scc1 H_WR
    s_ff1_i32_b32 s4, s9
    s_mov_b32 s64, 0
    s_mov_b32 s66, 0
    s_branch H_S0
H_TAKE:
    s_ff1_i32_b32 s5, s67
    s_bitset0_b32 s67, s5
H_WR:
    s_lshl_b32 s9, s5, 8
    s_or_b32 s15, s15, s9
    s_lshl_b32 s9, s4, 16
    s_or_b32 s15, s15, s9
    v_mov_b32 v20, s15
    ds_write_b32 v10, v20 offset:4
    v_mov_b32 v24, 0
    v_mov_b32 v25, 0
    v_mov_b32 v26, 0
    v_mov_b32 v27, 0
    ds_write_b128 v10, v[24:27] offset:16
    ds_write_b128 v10, v[24:27] offset:32
    ds_write_b128 v10, v[24:27] offset:48
    s_waitcnt lgkmcnt(0)
H_BAR:
    s_barrier
    ds_read_b32 v20, v10 offset:4
    s_waitcnt lgkmcnt(0)
    s_barrier
    v_readfirstlane_b32 s9, v20
    s_bfe_u32 s5, s9, 0x80008
    s_bfe_u32 s4, s9, 0x80010
    s_and_b32 s9, s9, 255
    s_cmp_eq_u32 s9, 0
    s_nop 0
    s_cbranch_scc1 LA_ENTRY
    s_cmp_eq_u32 s9, 1
    s_cbranch_scc1 LB_ENTRY
    s_cmp_eq_u32 s9, 2
    s_cbranch_scc1 LC_ENTRY
KF_END:
    s_endpgm
.section .rodata,"a"
.p2align 6
.amdhsa_kernel fused_kernel
  .amdhsa_next_free_vgpr 168
  .amdhsa_next_free_sgpr 102
  .amdhsa_accum_offset 168
  .amdhsa_group_segment_fixed_size 0
  .amdhsa_kernarg_size 88
  .amdhsa_user_sgpr_count 2
  .amdhsa_user_sgpr_kernarg_segment_ptr 1
  .amdhsa_system_sgpr_workgroup_id_x 1
.end_amdhsa_kernel
.text
```
